```python
import torch

def _softmax(x, axis=-1):
    return torch.softmax(x, dim=axis)
def _gelu(x):
    return torch.nn.functional.gelu(x, approximate="tanh")
def _silu(x):
    return torch.nn.functional.silu(x)
def _sigmoid(x):
    return torch.sigmoid(x)
def _layernorm(x, axis=-1, eps=1e-5):
    m = x.mean(dim=axis, keepdim=True)
    v = x.var(dim=axis, keepdim=True, unbiased=False)
    return (x - m) / torch.sqrt(v + eps)
def _scatter_add(tgt, idx, src, axis=0):
    return tgt.clone().index_add_(axis, idx, src)
def _segment_sum(src, seg, n):
    out = torch.zeros((n,) + src.shape[1:], dtype=src.dtype)
    return out.index_add_(0, seg, src)
def _pad(x, pw):
    flat = tuple(v for pair in reversed(pw) for v in pair)
    return torch.nn.functional.pad(x, flat)

kernel_name = 'recurrent_scan__gqa_block_cached__glu_gated_swiglu__decode'

def setup_inputs():

    _w = (lambda a: (lambda t: t.to(torch.bfloat16) if t.is_floating_point() else t)(torch.as_tensor(a)))
    def _A_setup():
        B, Sq, D = 1, 1, 512
        Hq, Hkv, Sk, Dh = 32, 8, 65536, 128
        assert Hq % Hkv == 0, (Hq, Hkv)
        return {
            "x": _w((lambda *s: torch.randn(*s, dtype=torch.bfloat16) * 0.4)(B, Sq, D)),
            "k_cache": _w((lambda *s: torch.randn(*s, dtype=torch.bfloat16) * 1.6)(B, Hkv, Sk, Dh)),
            "v_cache": _w((lambda *s: torch.randn(*s, dtype=torch.bfloat16) * 1.6)(B, Hkv, Sk, Dh)),
            "wq": _w((lambda *s: torch.randn(*s, dtype=torch.bfloat16) * 1.6)(D, Hq * Dh) * (D ** -0.5)),
            "wo": _w((lambda *s: torch.randn(*s, dtype=torch.bfloat16) * 1.6)(Hq * Dh, D) * ((Hq * Dh) ** -0.5)),
        }
    _A_in = _A_setup()

    def _B_setup():
        B, S, D, F = 1, 1, 512, 1792
        return {
            "x": _w((lambda *s: torch.randn(*s, dtype=torch.bfloat16) * 0.4)(B, S, D)),
            "w1": _w((lambda *s: torch.randn(*s, dtype=torch.bfloat16) * 1.6)(D, F) * (2.0 / D) ** 0.5),
            "w3": _w((lambda *s: torch.randn(*s, dtype=torch.bfloat16) * 1.6)(D, F) * (2.0 / D) ** 0.5),
            "w2": _w((lambda *s: torch.randn(*s, dtype=torch.bfloat16) * 1.6)(F, D) * (2.0 / F) ** 0.5),
        }
    _B_in = _B_setup()

    return {
        "A_x": _A_in["x"],
        "A_k_cache": _A_in["k_cache"],
        "A_v_cache": _A_in["v_cache"],
        "A_wq": _A_in["wq"],
        "A_wo": _A_in["wo"],
        "B_x": _B_in["x"],
        "B_w1": _B_in["w1"],
        "B_w3": _B_in["w3"],
        "B_w2": _B_in["w2"],
    }

def reference(A_x, A_k_cache, A_v_cache, A_wq, A_wo, B_x, B_w1, B_w3, B_w2):
    def _A_ref(x, k_cache, v_cache, wq, wo):
        B, Sq, D = x.shape
        Hq, Dh = 32, 128
        Hkv = k_cache.shape[1]
        rep = Hq // Hkv
        q = (lambda x, *d: x.permute(*d))((x @ wq).reshape(B, Sq, Hq, Dh), 0, 2, 1, 3)
        k = (lambda x, n, axis: torch.repeat_interleave(x, n, dim=axis))(k_cache, rep, axis=1)
        v = (lambda x, n, axis: torch.repeat_interleave(x, n, dim=axis))(v_cache, rep, axis=1)
        scores = torch.einsum("bhqd,bhkd->bhqk", q, k) * (Dh ** -0.5)
        p = _softmax(scores, axis=-1)
        o = torch.einsum("bhqk,bhkd->bhqd", p, v)
        return (lambda x, *d: x.permute(*d))(o, 0, 2, 1, 3).reshape(B, Sq, Hq * Dh) @ wo

    def _B_ref(x, w1, w3, w2):
        gate = torch.einsum("bsd,df->bsf", x, w1)
        up = torch.einsum("bsd,df->bsf", x, w3)
        h = _silu(gate) * up
        out = torch.einsum("bsf,fd->bsd", h, w2)
        return out

    x = A_x
    xn = _layernorm(x, axis=-1)
    s = _A_ref(xn, A_k_cache, A_v_cache, A_wq, A_wo)
    g = _silu(_B_ref(xn, B_w1, B_w3, B_w2))
    return x + s * g
```

```asm
; @launch grid=(256,1,1) block=(256,1,1) lds=37696
.amdgcn_target "amdgcn-amd-amdhsa--gfx950"
.text
.globl recurrent_scan__gqa_block_cached__glu_gated_swiglu__decode_kernel
.p2align 8
.type recurrent_scan__gqa_block_cached__glu_gated_swiglu__decode_kernel,@function
recurrent_scan__gqa_block_cached__glu_gated_swiglu__decode_kernel:
s_lshr_b32 s53, s2, 3
s_cmp_ge_u32 s53, 32
s_cbranch_scc1 L_end
s_load_dwordx2 s[8:9], s[0:1], 8
s_load_dwordx2 s[12:13], s[0:1], 16
s_load_dwordx2 s[24:25], s[0:1], 24
s_load_dwordx2 s[32:33], s[0:1], 0
s_load_dwordx2 s[16:17], s[0:1], 88
v_readfirstlane_b32 s3, v0
v_and_b32 v0, 63, v0
s_and_b32 s52, s2, 7
s_and_b32 s54, s53, 7
s_lshr_b32 s55, s53, 3
s_lshr_b32 s3, s3, 6
s_cbranch_scc1 L_stream
s_getpc_b64 s[4:5]
L_pc:
s_lshl_b32 s6, s53, 7
v_lshl_add_u32 v2, v0, 12, s6
v_cmp_gt_u32 vcc, L_end-L_pc, v2
s_setprio 3
s_mov_b64 exec, vcc
global_load_dword v247, v2, s[4:5]
s_mov_b64 exec, -1
v_lshlrev_b32 v2, 4, v0
v_lshrrev_b32 v4, 3, v0
v_and_b32 v5, 7, v0
v_lshlrev_b32 v6, 17, v4
v_lshl_add_u32 v6, v5, 4, v6
v_mov_b32 v21, 0
v_mov_b32 v20, 2056
s_mov_b32 s26, 0x400000
s_mov_b32 s27, 0x20000
s_mov_b32 s34, 0x400
s_mov_b32 s35, 0x20000
s_mov_b32 s18, 0x20000000
s_mov_b32 s19, 0x20000
s_lshl_b32 s66, s55, 20
s_lshl_b32 s68, s54, 10
s_add_u32 s66, s66, s68
s_lshl_b32 s68, s52, 7
s_add_u32 s66, s66, s68
s_waitcnt lgkmcnt(0)
buffer_load_dwordx4 v[8:11], v2, s[32:35], 0 offen
ds_write2_b32 v20, v21, v21 offset0:0 offset1:1
ds_write_b32 v20, v21 offset:8
buffer_load_dwordx4 v[64:67], v6, s[24:27], s66 offen nt
s_add_u32 s66, s66, 8192
buffer_load_dwordx4 v[68:71], v6, s[24:27], s66 offen nt
s_add_u32 s66, s66, 8192
buffer_load_dwordx4 v[72:75], v6, s[24:27], s66 offen nt
s_add_u32 s66, s66, 8192
buffer_load_dwordx4 v[76:79], v6, s[24:27], s66 offen nt
s_add_u32 s66, s66, 8192
buffer_load_dwordx4 v[80:83], v6, s[24:27], s66 offen nt
s_add_u32 s66, s66, 8192
buffer_load_dwordx4 v[84:87], v6, s[24:27], s66 offen nt
s_add_u32 s66, s66, 8192
buffer_load_dwordx4 v[88:91], v6, s[24:27], s66 offen nt
s_add_u32 s66, s66, 8192
buffer_load_dwordx4 v[92:95], v6, s[24:27], s66 offen nt
s_add_u32 s66, s66, 8192
buffer_load_dwordx4 v[96:99], v6, s[24:27], s66 offen nt
s_add_u32 s66, s66, 8192
buffer_load_dwordx4 v[100:103], v6, s[24:27], s66 offen nt
s_add_u32 s66, s66, 8192
buffer_load_dwordx4 v[104:107], v6, s[24:27], s66 offen nt
s_add_u32 s66, s66, 8192
buffer_load_dwordx4 v[108:111], v6, s[24:27], s66 offen nt
s_add_u32 s66, s66, 8192
buffer_load_dwordx4 v[112:115], v6, s[24:27], s66 offen nt
s_add_u32 s66, s66, 8192
buffer_load_dwordx4 v[116:119], v6, s[24:27], s66 offen nt
s_add_u32 s66, s66, 8192
buffer_load_dwordx4 v[120:123], v6, s[24:27], s66 offen nt
s_add_u32 s66, s66, 8192
buffer_load_dwordx4 v[124:127], v6, s[24:27], s66 offen nt
s_waitcnt lgkmcnt(0)
s_barrier
s_branch L_svc1
L_stream:
s_lshl_b32 s28, s54, 24
s_lshl_b32 s66, s52, 9
s_mul_i32 s67, s55, 3
s_add_u32 s66, s66, s67
s_add_u32 s66, s66, s3
s_sub_u32 s66, s66, 1
s_lshl_b32 s66, s66, 12
s_add_u32 s30, s28, s66
v_lshrrev_b32 v12, 4, v0
v_lshlrev_b32 v12, 6, v12
v_bfe_u32 v13, v0, 2, 2
v_and_b32 v14, 3, v0
v_lshl_add_u32 v12, v13, 8, v12
v_lshl_add_u32 v1, v14, 4, v12
v_lshlrev_b32 v2, 4, v0
s_mov_b32 s10, 0x8000000
s_mov_b32 s11, 0x20000
s_mov_b32 s14, 0x8000000
s_mov_b32 s15, 0x20000
s_waitcnt lgkmcnt(0)
s_barrier
s_mov_b32 s58, s30
buffer_load_dwordx4 a[32:35], v1, s[8:11], s30 offen offset:0 nt
buffer_load_dwordx4 a[36:39], v1, s[8:11], s30 offen offset:1024 nt
buffer_load_dwordx4 a[40:43], v1, s[8:11], s30 offen offset:2048 nt
buffer_load_dwordx4 a[44:47], v1, s[8:11], s30 offen offset:3072 nt
s_add_u32 s30, s30, 49152
buffer_load_dwordx4 a[48:51], v1, s[8:11], s30 offen offset:0 nt
buffer_load_dwordx4 a[52:55], v1, s[8:11], s30 offen offset:1024 nt
buffer_load_dwordx4 a[56:59], v1, s[8:11], s30 offen offset:2048 nt
buffer_load_dwordx4 a[60:63], v1, s[8:11], s30 offen offset:3072 nt
s_add_u32 s16, s16, 0
s_addc_u32 s17, s17, 0
s_mov_b32 s18, 0x20000000
s_mov_b32 s19, 0x20000
s_mov_b32 s34, 0x400
s_mov_b32 s35, 0x20000
s_load_dwordx2 s[20:21], s[0:1], 32
s_load_dwordx2 s[36:37], s[0:1], 72
s_load_dwordx2 s[40:41], s[0:1], 48
s_load_dwordx2 s[44:45], s[0:1], 56
s_load_dwordx2 s[48:49], s[0:1], 64
s_mov_b32 s22, 0x400000
s_mov_b32 s23, 0x20000
s_mov_b32 s38, 0x400
s_mov_b32 s39, 0x20000
s_mov_b32 s42, 0x1c0000
s_mov_b32 s43, 0x20000
s_mov_b32 s46, 0x1c0000
s_mov_b32 s47, 0x20000
s_mov_b32 s50, 0x1c0000
s_mov_b32 s51, 0x20000
s_mov_b32 s70, 0x05040100
s_mov_b32 s71, 0x07060302
s_mov_b32 s72, 0x3db504f3
s_mov_b32 s73, 0x3fb8aa3b
s_lshl_b32 s56, s55, 3
s_add_u32 s56, s56, s52
s_lshl_b32 s77, s52, 2
s_add_u32 s77, s77, s55
s_sub_u32 s66, s52, s53
s_and_b32 s66, s66, 7
s_cmp_eq_u32 s66, 4
s_cselect_b32 s59, s53, -1
v_mov_b32 v8, 0xff7fffff
v_mov_b32 v9, 0xff7fffff
v_mov_b32 v10, 0
v_mov_b32 v11, 0
v_mov_b32 v18, 2056
v_mov_b32 v52, 0
v_mov_b32 v53, 0
v_mov_b32 v54, 0
v_mov_b32 v55, 0
v_mov_b32 v56, 0
v_mov_b32 v57, 0
v_mov_b32 v58, 0
v_mov_b32 v59, 0
v_mov_b32 v60, 0
v_mov_b32 v61, 0
v_mov_b32 v62, 0
v_mov_b32 v63, 0
v_mov_b32 v64, 0
v_mov_b32 v65, 0
v_mov_b32 v66, 0
v_mov_b32 v67, 0
v_mov_b32 v68, 0
v_mov_b32 v69, 0
v_mov_b32 v70, 0
v_mov_b32 v71, 0
v_mov_b32 v72, 0
v_mov_b32 v73, 0
v_mov_b32 v74, 0
v_mov_b32 v75, 0
v_mov_b32 v76, 0
v_mov_b32 v77, 0
v_mov_b32 v78, 0
v_mov_b32 v79, 0
v_mov_b32 v80, 0
v_mov_b32 v81, 0
v_mov_b32 v82, 0
v_mov_b32 v83, 0
s_sub_u32 s66, s3, 1
s_mul_i32 s66, s66, 9728
s_add_u32 s66, s66, 8512
v_lshl_add_u32 v116, v0, 2, s66
s_mov_b32 s61, 1
s_add_u32 s31, s3, s52
s_lshl_b32 s66, s54, 10
s_add_u32 s66, s66, 131072
s_add_u32 s62, s16, s66
s_addc_u32 s63, s17, 0
s_mov_b32 s29, s55
s_add_u32 s30, s30, 49152
s_waitcnt vmcnt(4)
buffer_load_dwordx4 a[64:67], v1, s[8:11], s30 offen offset:0 nt
buffer_load_dwordx4 a[68:71], v1, s[8:11], s30 offen offset:1024 nt
buffer_load_dwordx4 a[72:75], v1, s[8:11], s30 offen offset:2048 nt
buffer_load_dwordx4 a[76:79], v1, s[8:11], s30 offen offset:3072 nt
s_add_u32 s30, s30, 49152
s_waitcnt vmcnt(4)
buffer_load_dwordx4 a[0:3], v1, s[8:11], s30 offen offset:0 nt
buffer_load_dwordx4 a[4:7], v1, s[8:11], s30 offen offset:1024 nt
buffer_load_dwordx4 a[8:11], v1, s[8:11], s30 offen offset:2048 nt
buffer_load_dwordx4 a[12:15], v1, s[8:11], s30 offen offset:3072 nt
s_add_u32 s30, s30, 49152
s_waitcnt vmcnt(4)
buffer_load_dwordx4 a[16:19], v1, s[8:11], s30 offen offset:0 nt
buffer_load_dwordx4 a[20:23], v1, s[8:11], s30 offen offset:1024 nt
buffer_load_dwordx4 a[24:27], v1, s[8:11], s30 offen offset:2048 nt
buffer_load_dwordx4 a[28:31], v1, s[8:11], s30 offen offset:3072 nt
s_add_u32 s30, s30, 49152
s_waitcnt vmcnt(4)
buffer_load_dwordx4 a[80:83], v1, s[8:11], s30 offen offset:0 nt
buffer_load_dwordx4 a[84:87], v1, s[8:11], s30 offen offset:1024 nt
buffer_load_dwordx4 a[88:91], v1, s[8:11], s30 offen offset:2048 nt
buffer_load_dwordx4 a[92:95], v1, s[8:11], s30 offen offset:3072 nt
s_add_u32 s30, s30, 49152
s_waitcnt vmcnt(4)
buffer_load_dwordx4 a[96:99], v1, s[8:11], s30 offen offset:0 nt
buffer_load_dwordx4 a[100:103], v1, s[8:11], s30 offen offset:1024 nt
buffer_load_dwordx4 a[104:107], v1, s[8:11], s30 offen offset:2048 nt
buffer_load_dwordx4 a[108:111], v1, s[8:11], s30 offen offset:3072 nt
s_add_u32 s30, s30, 49152
s_waitcnt vmcnt(4)
buffer_load_dwordx4 a[112:115], v1, s[8:11], s30 offen offset:0 nt
buffer_load_dwordx4 a[116:119], v1, s[8:11], s30 offen offset:1024 nt
buffer_load_dwordx4 a[120:123], v1, s[8:11], s30 offen offset:2048 nt
buffer_load_dwordx4 a[124:127], v1, s[8:11], s30 offen offset:3072 nt
ds_write_b32 v18, v18 offset:4
s_add_u32 s30, s30, 49152
s_waitcnt vmcnt(4)
buffer_load_dwordx4 a[128:131], v1, s[8:11], s30 offen offset:0 nt
buffer_load_dwordx4 a[132:135], v1, s[8:11], s30 offen offset:1024 nt
buffer_load_dwordx4 a[136:139], v1, s[8:11], s30 offen offset:2048 nt
buffer_load_dwordx4 a[140:143], v1, s[8:11], s30 offen offset:3072 nt
s_add_u32 s30, s30, 49152
s_waitcnt vmcnt(4)
buffer_load_dwordx4 a[144:147], v1, s[8:11], s30 offen offset:0 nt
buffer_load_dwordx4 a[148:151], v1, s[8:11], s30 offen offset:1024 nt
buffer_load_dwordx4 a[152:155], v1, s[8:11], s30 offen offset:2048 nt
buffer_load_dwordx4 a[156:159], v1, s[8:11], s30 offen offset:3072 nt
s_add_u32 s30, s30, 49152
s_waitcnt vmcnt(4)
buffer_load_dwordx4 a[160:163], v1, s[8:11], s30 offen offset:0 nt
buffer_load_dwordx4 a[164:167], v1, s[8:11], s30 offen offset:1024 nt
buffer_load_dwordx4 a[168:171], v1, s[8:11], s30 offen offset:2048 nt
buffer_load_dwordx4 a[172:175], v1, s[8:11], s30 offen offset:3072 nt
s_add_u32 s30, s30, 49152
s_waitcnt vmcnt(4)
buffer_load_dwordx4 a[176:179], v1, s[8:11], s30 offen offset:0 nt
buffer_load_dwordx4 a[180:183], v1, s[8:11], s30 offen offset:1024 nt
buffer_load_dwordx4 a[184:187], v1, s[8:11], s30 offen offset:2048 nt
buffer_load_dwordx4 a[188:191], v1, s[8:11], s30 offen offset:3072 nt
s_add_u32 s30, s30, 49152
s_waitcnt vmcnt(4)
buffer_load_dwordx4 a[192:195], v1, s[8:11], s30 offen offset:0 nt
buffer_load_dwordx4 a[196:199], v1, s[8:11], s30 offen offset:1024 nt
buffer_load_dwordx4 a[200:203], v1, s[8:11], s30 offen offset:2048 nt
buffer_load_dwordx4 a[204:207], v1, s[8:11], s30 offen offset:3072 nt
s_branch L_backlog
L_svc1:
s_add_u32 s16, s16, 0
s_addc_u32 s17, s17, 0
s_mov_b32 s68, 163840
buffer_load_dwordx2 v[58:59], v21, s[16:19], s68 offen sc1
s_lshl_b32 s67, s53, 10
s_add_u32 s67, s67, 131072
s_lshl_b32 s68, s52, 7
s_add_u32 s67, s67, s68
s_cmp_lg_u32 s52, 0
s_cbranch_scc1 L_noini
s_mov_b64 exec, 1
buffer_store_dword v21, v21, s[16:19], s67 offen sc1
s_mov_b64 exec, -1
s_waitcnt vmcnt(18)
L_noini:
s_load_dwordx2 s[20:21], s[0:1], 32
s_load_dwordx2 s[36:37], s[0:1], 72
s_load_dwordx2 s[40:41], s[0:1], 48
s_load_dwordx2 s[44:45], s[0:1], 56
s_load_dwordx2 s[48:49], s[0:1], 64
s_mov_b32 s22, 0x400000
s_mov_b32 s23, 0x20000
s_mov_b32 s38, 0x400
s_mov_b32 s39, 0x20000
s_mov_b32 s42, 0x1c0000
s_mov_b32 s43, 0x20000
s_mov_b32 s46, 0x1c0000
s_mov_b32 s47, 0x20000
s_mov_b32 s50, 0x1c0000
s_mov_b32 s51, 0x20000
s_mov_b32 s70, 0x05040100
s_mov_b32 s71, 0x07060302
s_mov_b32 s72, 0x3db504f3
s_mov_b32 s73, 0x3fb8aa3b
s_lshl_b32 s56, s55, 3
s_add_u32 s56, s56, s52
s_lshl_b32 s77, s52, 2
s_add_u32 s77, s77, s55
s_sub_u32 s66, s52, s53
s_and_b32 s66, s66, 7
s_cmp_eq_u32 s66, 4
s_cselect_b32 s59, s53, -1
v_bfe_u32 v22, v0, 5, 1
v_bfe_u32 v23, v0, 4, 1
v_lshlrev_b32 v22, 2, v22
v_lshl_add_u32 v22, v23, 1, v22
v_bfe_u32 v23, v0, 3, 1
v_add_u32 v22, v22, v23
v_lshl_add_u32 v22, v5, 3, v22
v_lshlrev_b32 v23, 3, v22
s_lshl_b32 s66, s55, 8
v_lshl_add_u32 v20, v4, 5, s66
s_cmp_eq_u32 s52, 0
s_cbranch_scc1 L_xw
s_waitcnt vmcnt(17)
L_xw:
v_lshlrev_b32 v24, 16, v8
v_and_b32 v25, 0xffff0000, v8
v_lshlrev_b32 v26, 16, v9
v_and_b32 v27, 0xffff0000, v9
v_lshlrev_b32 v28, 16, v10
v_and_b32 v29, 0xffff0000, v10
v_lshlrev_b32 v30, 16, v11
v_and_b32 v31, 0xffff0000, v11
v_add_f32 v32, v24, v25
v_add_f32 v33, v26, v27
v_add_f32 v34, v28, v29
v_add_f32 v35, v30, v31
v_add_f32 v32, v32, v33
v_add_f32 v34, v34, v35
v_add_f32 v32, v32, v34
s_nop 1
v_add_f32_dpp v32, v32, v32 row_ror:8 row_mask:0xf bank_mask:0xf
s_nop 1
v_add_f32_dpp v32, v32, v32 row_ror:4 row_mask:0xf bank_mask:0xf
s_nop 1
v_add_f32_dpp v32, v32, v32 row_ror:2 row_mask:0xf bank_mask:0xf
s_nop 1
v_add_f32_dpp v32, v32, v32 row_ror:1 row_mask:0xf bank_mask:0xf
v_mov_b32 v33, v32
s_nop 1
v_permlane16_swap_b32 v33, v32
v_add_f32 v32, v32, v33
v_mov_b32 v33, v32
s_nop 1
v_permlane32_swap_b32 v33, v32
v_add_f32 v32, v32, v33
v_mul_f32 v32, 0x3b000000, v32
v_sub_f32 v40, v24, v32
v_sub_f32 v41, v25, v32
v_sub_f32 v42, v26, v32
v_sub_f32 v43, v27, v32
v_sub_f32 v44, v28, v32
v_sub_f32 v45, v29, v32
v_sub_f32 v46, v30, v32
v_sub_f32 v47, v31, v32
v_mul_f32 v34, v40, v40
v_mul_f32 v35, v41, v41
v_fmac_f32 v34, v42, v42
v_fmac_f32 v35, v43, v43
v_fmac_f32 v34, v44, v44
v_fmac_f32 v35, v45, v45
v_fmac_f32 v34, v46, v46
v_fmac_f32 v35, v47, v47
v_add_f32 v34, v34, v35
s_nop 1
v_add_f32_dpp v34, v34, v34 row_ror:8 row_mask:0xf bank_mask:0xf
s_nop 1
v_add_f32_dpp v34, v34, v34 row_ror:4 row_mask:0xf bank_mask:0xf
s_nop 1
v_add_f32_dpp v34, v34, v34 row_ror:2 row_mask:0xf bank_mask:0xf
s_nop 1
v_add_f32_dpp v34, v34, v34 row_ror:1 row_mask:0xf bank_mask:0xf
v_mov_b32 v33, v34
s_nop 1
v_permlane16_swap_b32 v33, v34
v_add_f32 v34, v34, v33
v_mov_b32 v33, v34
s_nop 1
v_permlane32_swap_b32 v33, v34
v_add_f32 v34, v34, v33
v_mul_f32 v34, 0x3b000000, v34
v_cvt_pk_bf16_f32 v32, v32, v32
v_lshlrev_b32 v32, 16, v32
v_cvt_pk_bf16_f32 v34, v34, v34
v_lshlrev_b32 v34, 16, v34
v_add_f32 v34, 0x3727c5ac, v34
v_cvt_pk_bf16_f32 v34, v34, v34
v_lshlrev_b32 v34, 16, v34
v_sqrt_f32 v34, v34
s_nop 0
v_cvt_pk_bf16_f32 v34, v34, v34
v_lshlrev_b32 v34, 16, v34
v_rcp_f32 v34, v34
v_sub_f32 v40, v24, v32
v_sub_f32 v41, v25, v32
v_sub_f32 v42, v26, v32
v_sub_f32 v43, v27, v32
v_sub_f32 v44, v28, v32
v_sub_f32 v45, v29, v32
v_sub_f32 v46, v30, v32
v_sub_f32 v47, v31, v32
v_cvt_pk_bf16_f32 v48, v40, v41
v_cvt_pk_bf16_f32 v49, v42, v43
v_cvt_pk_bf16_f32 v50, v44, v45
v_cvt_pk_bf16_f32 v51, v46, v47
v_lshlrev_b32 v40, 16, v48
v_and_b32 v41, 0xffff0000, v48
v_lshlrev_b32 v42, 16, v49
v_and_b32 v43, 0xffff0000, v49
v_lshlrev_b32 v44, 16, v50
v_and_b32 v45, 0xffff0000, v50
v_lshlrev_b32 v46, 16, v51
v_and_b32 v47, 0xffff0000, v51
v_mul_f32 v40, v40, v34
v_mul_f32 v41, v41, v34
v_mul_f32 v42, v42, v34
v_mul_f32 v43, v43, v34
v_mul_f32 v44, v44, v34
v_mul_f32 v45, v45, v34
v_mul_f32 v46, v46, v34
v_mul_f32 v47, v47, v34
v_cvt_pk_bf16_f32 v48, v40, v41
v_cvt_pk_bf16_f32 v49, v42, v43
v_cvt_pk_bf16_f32 v50, v44, v45
v_cvt_pk_bf16_f32 v51, v46, v47
ds_write_b128 v2, v[48:51] offset:0
s_waitcnt lgkmcnt(0)
ds_read_b128 v[24:27], v20 offset:0
ds_read_b128 v[28:31], v20 offset:16
s_waitcnt lgkmcnt(0)
s_waitcnt vmcnt(15)
v_perm_b32 v60, v68, v64, s70
v_dot2_f32_bf16 v40, v60, v24, 0
v_perm_b32 v61, v68, v64, s71
v_dot2_f32_bf16 v41, v61, v24, 0
v_perm_b32 v62, v69, v65, s70
v_dot2_f32_bf16 v42, v62, v24, 0
v_perm_b32 v63, v69, v65, s71
v_dot2_f32_bf16 v43, v63, v24, 0
v_perm_b32 v60, v70, v66, s70
v_dot2_f32_bf16 v44, v60, v24, 0
v_perm_b32 v61, v70, v66, s71
v_dot2_f32_bf16 v45, v61, v24, 0
v_perm_b32 v62, v71, v67, s70
v_dot2_f32_bf16 v46, v62, v24, 0
v_perm_b32 v63, v71, v67, s71
v_dot2_f32_bf16 v47, v63, v24, 0
s_waitcnt vmcnt(13)
v_perm_b32 v60, v76, v72, s70
v_dot2_f32_bf16 v40, v60, v25, v40
v_perm_b32 v61, v76, v72, s71
v_dot2_f32_bf16 v41, v61, v25, v41
v_perm_b32 v62, v77, v73, s70
v_dot2_f32_bf16 v42, v62, v25, v42
v_perm_b32 v63, v77, v73, s71
v_dot2_f32_bf16 v43, v63, v25, v43
v_perm_b32 v60, v78, v74, s70
v_dot2_f32_bf16 v44, v60, v25, v44
v_perm_b32 v61, v78, v74, s71
v_dot2_f32_bf16 v45, v61, v25, v45
v_perm_b32 v62, v79, v75, s70
v_dot2_f32_bf16 v46, v62, v25, v46
v_perm_b32 v63, v79, v75, s71
v_dot2_f32_bf16 v47, v63, v25, v47
s_waitcnt vmcnt(11)
v_perm_b32 v60, v84, v80, s70
v_dot2_f32_bf16 v40, v60, v26, v40
v_perm_b32 v61, v84, v80, s71
v_dot2_f32_bf16 v41, v61, v26, v41
v_perm_b32 v62, v85, v81, s70
v_dot2_f32_bf16 v42, v62, v26, v42
v_perm_b32 v63, v85, v81, s71
v_dot2_f32_bf16 v43, v63, v26, v43
v_perm_b32 v60, v86, v82, s70
v_dot2_f32_bf16 v44, v60, v26, v44
v_perm_b32 v61, v86, v82, s71
v_dot2_f32_bf16 v45, v61, v26, v45
v_perm_b32 v62, v87, v83, s70
v_dot2_f32_bf16 v46, v62, v26, v46
v_perm_b32 v63, v87, v83, s71
v_dot2_f32_bf16 v47, v63, v26, v47
s_waitcnt vmcnt(9)
v_perm_b32 v60, v92, v88, s70
v_dot2_f32_bf16 v40, v60, v27, v40
v_perm_b32 v61, v92, v88, s71
v_dot2_f32_bf16 v41, v61, v27, v41
v_perm_b32 v62, v93, v89, s70
v_dot2_f32_bf16 v42, v62, v27, v42
v_perm_b32 v63, v93, v89, s71
v_dot2_f32_bf16 v43, v63, v27, v43
v_perm_b32 v60, v94, v90, s70
v_dot2_f32_bf16 v44, v60, v27, v44
v_perm_b32 v61, v94, v90, s71
v_dot2_f32_bf16 v45, v61, v27, v45
v_perm_b32 v62, v95, v91, s70
v_dot2_f32_bf16 v46, v62, v27, v46
v_perm_b32 v63, v95, v91, s71
v_dot2_f32_bf16 v47, v63, v27, v47
s_waitcnt vmcnt(7)
v_perm_b32 v60, v100, v96, s70
v_dot2_f32_bf16 v40, v60, v28, v40
v_perm_b32 v61, v100, v96, s71
v_dot2_f32_bf16 v41, v61, v28, v41
v_perm_b32 v62, v101, v97, s70
v_dot2_f32_bf16 v42, v62, v28, v42
v_perm_b32 v63, v101, v97, s71
v_dot2_f32_bf16 v43, v63, v28, v43
v_perm_b32 v60, v102, v98, s70
v_dot2_f32_bf16 v44, v60, v28, v44
v_perm_b32 v61, v102, v98, s71
v_dot2_f32_bf16 v45, v61, v28, v45
v_perm_b32 v62, v103, v99, s70
v_dot2_f32_bf16 v46, v62, v28, v46
v_perm_b32 v63, v103, v99, s71
v_dot2_f32_bf16 v47, v63, v28, v47
s_waitcnt vmcnt(5)
v_perm_b32 v60, v108, v104, s70
v_dot2_f32_bf16 v40, v60, v29, v40
v_perm_b32 v61, v108, v104, s71
v_dot2_f32_bf16 v41, v61, v29, v41
v_perm_b32 v62, v109, v105, s70
v_dot2_f32_bf16 v42, v62, v29, v42
v_perm_b32 v63, v109, v105, s71
v_dot2_f32_bf16 v43, v63, v29, v43
v_perm_b32 v60, v110, v106, s70
v_dot2_f32_bf16 v44, v60, v29, v44
v_perm_b32 v61, v110, v106, s71
v_dot2_f32_bf16 v45, v61, v29, v45
v_perm_b32 v62, v111, v107, s70
v_dot2_f32_bf16 v46, v62, v29, v46
v_perm_b32 v63, v111, v107, s71
v_dot2_f32_bf16 v47, v63, v29, v47
s_waitcnt vmcnt(3)
v_perm_b32 v60, v116, v112, s70
v_dot2_f32_bf16 v40, v60, v30, v40
v_perm_b32 v61, v116, v112, s71
v_dot2_f32_bf16 v41, v61, v30, v41
v_perm_b32 v62, v117, v113, s70
v_dot2_f32_bf16 v42, v62, v30, v42
v_perm_b32 v63, v117, v113, s71
v_dot2_f32_bf16 v43, v63, v30, v43
v_perm_b32 v60, v118, v114, s70
v_dot2_f32_bf16 v44, v60, v30, v44
v_perm_b32 v61, v118, v114, s71
v_dot2_f32_bf16 v45, v61, v30, v45
v_perm_b32 v62, v119, v115, s70
v_dot2_f32_bf16 v46, v62, v30, v46
v_perm_b32 v63, v119, v115, s71
v_dot2_f32_bf16 v47, v63, v30, v47
s_waitcnt vmcnt(1)
v_perm_b32 v60, v124, v120, s70
v_dot2_f32_bf16 v40, v60, v31, v40
v_perm_b32 v61, v124, v120, s71
v_dot2_f32_bf16 v41, v61, v31, v41
v_perm_b32 v62, v125, v121, s70
v_dot2_f32_bf16 v42, v62, v31, v42
v_perm_b32 v63, v125, v121, s71
v_dot2_f32_bf16 v43, v63, v31, v43
v_perm_b32 v60, v126, v122, s70
v_dot2_f32_bf16 v44, v60, v31, v44
v_perm_b32 v61, v126, v122, s71
v_dot2_f32_bf16 v45, v61, v31, v45
v_perm_b32 v62, v127, v123, s70
v_dot2_f32_bf16 v46, v62, v31, v46
v_perm_b32 v63, v127, v123, s71
v_dot2_f32_bf16 v47, v63, v31, v47
v_permlane32_swap_b32 v40, v44
v_permlane32_swap_b32 v41, v45
v_permlane32_swap_b32 v42, v46
v_permlane32_swap_b32 v43, v47
v_add_f32 v40, v40, v44
v_add_f32 v41, v41, v45
v_add_f32 v42, v42, v46
v_add_f32 v43, v43, v47
s_nop 0
v_permlane16_swap_b32 v40, v42
v_permlane16_swap_b32 v41, v43
v_add_f32 v40, v40, v42
v_add_f32 v41, v41, v43
s_lshl_b32 s69, s54, 14
s_lshl_b32 s68, s56, 9
s_add_u32 s66, s69, s68
v_add_f32_dpp v56, v40, v40 row_ror:8 row_mask:0xf bank_mask:0xf
v_add_f32_dpp v57, v41, v41 row_ror:8 row_mask:0xf bank_mask:0xf
s_mov_b32 s67, 1664525
s_waitcnt vmcnt(0)
v_mul_lo_u32 v58, v58, s67
v_add_u32 v58, 0x3c6ef35f, v58
s_mov_b32 exec_lo, 0x00ff00ff
s_mov_b32 exec_hi, 0x00ff00ff
buffer_store_dwordx4 v[56:59], v23, s[16:19], s66 offen sc1
s_mov_b64 exec, -1
ds_write_b64 v21, v[58:59] offset:2048
s_mov_b32 s74, 1048576
L_wq:
s_sleep 1
ds_read_b32 v33, v21 offset:2060
s_sub_u32 s74, s74, 1
s_cbranch_scc1 L_wq_d
s_waitcnt lgkmcnt(0)
v_cmp_eq_u32 vcc, 0, v33
s_cbranch_vccnz L_wq
L_wq_d:
s_waitcnt lgkmcnt(0)
s_mov_b32 s74, 1048576
L_pollq:
s_mov_b32 s66, s69
buffer_load_dwordx4 v[64:67], v2, s[16:19], s66 offen offset:0 sc1
buffer_load_dwordx4 v[68:71], v2, s[16:19], s66 offen offset:1024 sc1
buffer_load_dwordx4 v[72:75], v2, s[16:19], s66 offen offset:2048 sc1
buffer_load_dwordx4 v[76:79], v2, s[16:19], s66 offen offset:3072 sc1
s_add_u32 s66, s66, 4096
buffer_load_dwordx4 v[80:83], v2, s[16:19], s66 offen offset:0 sc1
buffer_load_dwordx4 v[84:87], v2, s[16:19], s66 offen offset:1024 sc1
buffer_load_dwordx4 v[88:91], v2, s[16:19], s66 offen offset:2048 sc1
buffer_load_dwordx4 v[92:95], v2, s[16:19], s66 offen offset:3072 sc1
s_add_u32 s66, s66, 4096
buffer_load_dwordx4 v[96:99], v2, s[16:19], s66 offen offset:0 sc1
buffer_load_dwordx4 v[100:103], v2, s[16:19], s66 offen offset:1024 sc1
buffer_load_dwordx4 v[104:107], v2, s[16:19], s66 offen offset:2048 sc1
buffer_load_dwordx4 v[108:111], v2, s[16:19], s66 offen offset:3072 sc1
s_add_u32 s66, s66, 4096
buffer_load_dwordx4 v[112:115], v2, s[16:19], s66 offen offset:0 sc1
buffer_load_dwordx4 v[116:119], v2, s[16:19], s66 offen offset:1024 sc1
buffer_load_dwordx4 v[120:123], v2, s[16:19], s66 offen offset:2048 sc1
buffer_load_dwordx4 v[124:127], v2, s[16:19], s66 offen offset:3072 sc1
s_sub_u32 s74, s74, 1
s_cbranch_scc1 L_pollq_done
s_waitcnt vmcnt(0)
v_xor_b32 v33, v66, v58
v_bitop3_b32 v33, v67, v59, v33 bitop3:0xbe
v_bitop3_b32 v33, v70, v58, v33 bitop3:0xbe
v_bitop3_b32 v33, v71, v59, v33 bitop3:0xbe
v_bitop3_b32 v33, v74, v58, v33 bitop3:0xbe
v_bitop3_b32 v33, v75, v59, v33 bitop3:0xbe
v_bitop3_b32 v33, v78, v58, v33 bitop3:0xbe
v_bitop3_b32 v33, v79, v59, v33 bitop3:0xbe
v_bitop3_b32 v33, v82, v58, v33 bitop3:0xbe
v_bitop3_b32 v33, v83, v59, v33 bitop3:0xbe
v_bitop3_b32 v33, v86, v58, v33 bitop3:0xbe
v_bitop3_b32 v33, v87, v59, v33 bitop3:0xbe
v_bitop3_b32 v33, v90, v58, v33 bitop3:0xbe
v_bitop3_b32 v33, v91, v59, v33 bitop3:0xbe
v_bitop3_b32 v33, v94, v58, v33 bitop3:0xbe
v_bitop3_b32 v33, v95, v59, v33 bitop3:0xbe
v_bitop3_b32 v33, v98, v58, v33 bitop3:0xbe
v_bitop3_b32 v33, v99, v59, v33 bitop3:0xbe
v_bitop3_b32 v33, v102, v58, v33 bitop3:0xbe
v_bitop3_b32 v33, v103, v59, v33 bitop3:0xbe
v_bitop3_b32 v33, v106, v58, v33 bitop3:0xbe
v_bitop3_b32 v33, v107, v59, v33 bitop3:0xbe
v_bitop3_b32 v33, v110, v58, v33 bitop3:0xbe
v_bitop3_b32 v33, v111, v59, v33 bitop3:0xbe
v_bitop3_b32 v33, v114, v58, v33 bitop3:0xbe
v_bitop3_b32 v33, v115, v59, v33 bitop3:0xbe
v_bitop3_b32 v33, v118, v58, v33 bitop3:0xbe
v_bitop3_b32 v33, v119, v59, v33 bitop3:0xbe
v_bitop3_b32 v33, v122, v58, v33 bitop3:0xbe
v_bitop3_b32 v33, v123, v59, v33 bitop3:0xbe
v_bitop3_b32 v33, v126, v58, v33 bitop3:0xbe
v_bitop3_b32 v33, v127, v59, v33 bitop3:0xbe
v_cmp_ne_u32 vcc, 0, v33
s_cbranch_vccnz L_pollq
L_pollq_done:
s_waitcnt vmcnt(0)
v_add_f32 v64, v64, v80
v_add_f32 v96, v96, v112
v_add_f32 v64, v64, v96
v_add_f32 v65, v65, v81
v_add_f32 v97, v97, v113
v_add_f32 v65, v65, v97
v_add_f32 v68, v68, v84
v_add_f32 v100, v100, v116
v_add_f32 v68, v68, v100
v_add_f32 v69, v69, v85
v_add_f32 v101, v101, v117
v_add_f32 v69, v69, v101
v_add_f32 v72, v72, v88
v_add_f32 v104, v104, v120
v_add_f32 v72, v72, v104
v_add_f32 v73, v73, v89
v_add_f32 v105, v105, v121
v_add_f32 v73, v73, v105
v_add_f32 v76, v76, v92
v_add_f32 v108, v108, v124
v_add_f32 v76, v76, v108
v_add_f32 v77, v77, v93
v_add_f32 v109, v109, v125
v_add_f32 v77, v77, v109
v_lshrrev_b32 v34, 2, v0
v_and_b32 v35, 3, v0
v_lshlrev_b32 v34, 6, v34
v_lshl_add_u32 v34, v35, 2, v34
v_cvt_pk_bf16_f32 v48, v64, v65
v_cvt_pk_bf16_f32 v49, v68, v69
v_cvt_pk_bf16_f32 v50, v72, v73
v_cvt_pk_bf16_f32 v51, v76, v77
ds_write_b32 v34, v48 offset:1024
ds_write_b32 v34, v49 offset:1040
ds_write_b32 v34, v50 offset:1056
ds_write_b32 v34, v51 offset:1072
s_waitcnt lgkmcnt(0)
s_barrier
s_setprio 0
s_branch L_svc2
L_backlog:
s_barrier
ds_read_b128 v[4:7], v2 offset:1024
s_waitcnt lgkmcnt(0)
s_waitcnt vmcnt(48)
v_mfma_f32_16x16x32_bf16 v[20:23], a[32:35], v[4:7], 0
v_mfma_f32_16x16x32_bf16 v[24:27], a[36:39], v[4:7], 0
v_mfma_f32_16x16x32_bf16 v[28:31], a[40:43], v[4:7], 0
v_mfma_f32_16x16x32_bf16 v[32:35], a[44:47], v[4:7], 0
s_nop 4
v_add_f32_dpp v12, v21, v20 row_ror:12 row_mask:0xf bank_mask:0x1
v_add_f32_dpp v13, v24, v25 row_ror:4 row_mask:0xf bank_mask:0x2
v_add_f32_dpp v14, v28, v30 row_ror:8 row_mask:0xf bank_mask:0x4
v_add_f32_dpp v15, v32, v35 row_ror:12 row_mask:0xf bank_mask:0x8
v_add_f32_dpp v12, v22, v12 row_ror:8 row_mask:0xf bank_mask:0x1
v_add_f32_dpp v13, v26, v13 row_ror:12 row_mask:0xf bank_mask:0x2
v_add_f32_dpp v14, v29, v14 row_ror:4 row_mask:0xf bank_mask:0x4
v_add_f32_dpp v15, v33, v15 row_ror:8 row_mask:0xf bank_mask:0x8
v_add_f32_dpp v11, v23, v12 row_ror:4 row_mask:0xf bank_mask:0x1
s_nop 1
v_add_f32_dpp v11, v27, v13 row_ror:8 row_mask:0xf bank_mask:0x2
s_nop 1
v_add_f32_dpp v11, v31, v14 row_ror:12 row_mask:0xf bank_mask:0x4
s_nop 1
v_add_f32_dpp v11, v34, v15 row_ror:4 row_mask:0xf bank_mask:0x8
v_cvt_pk_bf16_f32 v12, v11, v11
v_lshlrev_b32 v12, 16, v12
v_mul_f32 v12, s72, v12
v_cvt_pk_bf16_f32 v12, v12, v12
v_lshlrev_b32 v12, 16, v12
v_max_f32 v8, v8, v12
ds_write_b32 v116, v12 offset:0
s_waitcnt vmcnt(44)
v_mfma_f32_16x16x32_bf16 v[20:23], a[48:51], v[4:7], 0
v_mfma_f32_16x16x32_bf16 v[24:27], a[52:55], v[4:7], 0
v_mfma_f32_16x16x32_bf16 v[28:31], a[56:59], v[4:7], 0
v_mfma_f32_16x16x32_bf16 v[32:35], a[60:63], v[4:7], 0
s_nop 4
v_add_f32_dpp v12, v21, v20 row_ror:12 row_mask:0xf bank_mask:0x1
v_add_f32_dpp v13, v24, v25 row_ror:4 row_mask:0xf bank_mask:0x2
v_add_f32_dpp v14, v28, v30 row_ror:8 row_mask:0xf bank_mask:0x4
v_add_f32_dpp v15, v32, v35 row_ror:12 row_mask:0xf bank_mask:0x8
v_add_f32_dpp v12, v22, v12 row_ror:8 row_mask:0xf bank_mask:0x1
v_add_f32_dpp v13, v26, v13 row_ror:12 row_mask:0xf bank_mask:0x2
v_add_f32_dpp v14, v29, v14 row_ror:4 row_mask:0xf bank_mask:0x4
v_add_f32_dpp v15, v33, v15 row_ror:8 row_mask:0xf bank_mask:0x8
v_add_f32_dpp v11, v23, v12 row_ror:4 row_mask:0xf bank_mask:0x1
s_nop 1
v_add_f32_dpp v11, v27, v13 row_ror:8 row_mask:0xf bank_mask:0x2
s_nop 1
v_add_f32_dpp v11, v31, v14 row_ror:12 row_mask:0xf bank_mask:0x4
s_nop 1
v_add_f32_dpp v11, v34, v15 row_ror:4 row_mask:0xf bank_mask:0x8
v_cvt_pk_bf16_f32 v12, v11, v11
v_lshlrev_b32 v12, 16, v12
v_mul_f32 v12, s72, v12
v_cvt_pk_bf16_f32 v12, v12, v12
v_lshlrev_b32 v12, 16, v12
v_max_f32 v8, v8, v12
ds_write_b32 v116, v12 offset:256
s_waitcnt vmcnt(40)
v_mfma_f32_16x16x32_bf16 v[20:23], a[64:67], v[4:7], 0
v_mfma_f32_16x16x32_bf16 v[24:27], a[68:71], v[4:7], 0
v_mfma_f32_16x16x32_bf16 v[28:31], a[72:75], v[4:7], 0
v_mfma_f32_16x16x32_bf16 v[32:35], a[76:79], v[4:7], 0
s_nop 4
v_add_f32_dpp v12, v21, v20 row_ror:12 row_mask:0xf bank_mask:0x1
v_add_f32_dpp v13, v24, v25 row_ror:4 row_mask:0xf bank_mask:0x2
v_add_f32_dpp v14, v28, v30 row_ror:8 row_mask:0xf bank_mask:0x4
v_add_f32_dpp v15, v32, v35 row_ror:12 row_mask:0xf bank_mask:0x8
v_add_f32_dpp v12, v22, v12 row_ror:8 row_mask:0xf bank_mask:0x1
v_add_f32_dpp v13, v26, v13 row_ror:12 row_mask:0xf bank_mask:0x2
v_add_f32_dpp v14, v29, v14 row_ror:4 row_mask:0xf bank_mask:0x4
v_add_f32_dpp v15, v33, v15 row_ror:8 row_mask:0xf bank_mask:0x8
v_add_f32_dpp v11, v23, v12 row_ror:4 row_mask:0xf bank_mask:0x1
s_nop 1
v_add_f32_dpp v11, v27, v13 row_ror:8 row_mask:0xf bank_mask:0x2
s_nop 1
v_add_f32_dpp v11, v31, v14 row_ror:12 row_mask:0xf bank_mask:0x4
s_nop 1
v_add_f32_dpp v11, v34, v15 row_ror:4 row_mask:0xf bank_mask:0x8
v_cvt_pk_bf16_f32 v12, v11, v11
v_lshlrev_b32 v12, 16, v12
v_mul_f32 v12, s72, v12
v_cvt_pk_bf16_f32 v12, v12, v12
v_lshlrev_b32 v12, 16, v12
v_max_f32 v8, v8, v12
ds_write_b32 v116, v12 offset:512
s_waitcnt vmcnt(36)
v_mfma_f32_16x16x32_bf16 v[20:23], a[0:3], v[4:7], 0
v_mfma_f32_16x16x32_bf16 v[24:27], a[4:7], v[4:7], 0
v_mfma_f32_16x16x32_bf16 v[28:31], a[8:11], v[4:7], 0
v_mfma_f32_16x16x32_bf16 v[32:35], a[12:15], v[4:7], 0
s_add_u32 s30, s30, 49152
s_waitcnt vmcnt(4)
buffer_load_dwordx4 a[32:35], v1, s[8:11], s30 offen offset:0 nt
buffer_load_dwordx4 a[36:39], v1, s[8:11], s30 offen offset:1024 nt
buffer_load_dwordx4 a[40:43], v1, s[8:11], s30 offen offset:2048 nt
buffer_load_dwordx4 a[44:47], v1, s[8:11], s30 offen offset:3072 nt
v_add_f32_dpp v12, v21, v20 row_ror:12 row_mask:0xf bank_mask:0x1
v_add_f32_dpp v13, v24, v25 row_ror:4 row_mask:0xf bank_mask:0x2
v_add_f32_dpp v14, v28, v30 row_ror:8 row_mask:0xf bank_mask:0x4
v_add_f32_dpp v15, v32, v35 row_ror:12 row_mask:0xf bank_mask:0x8
v_add_f32_dpp v12, v22, v12 row_ror:8 row_mask:0xf bank_mask:0x1
v_add_f32_dpp v13, v26, v13 row_ror:12 row_mask:0xf bank_mask:0x2
v_add_f32_dpp v14, v29, v14 row_ror:4 row_mask:0xf bank_mask:0x4
v_add_f32_dpp v15, v33, v15 row_ror:8 row_mask:0xf bank_mask:0x8
v_add_f32_dpp v11, v23, v12 row_ror:4 row_mask:0xf bank_mask:0x1
s_nop 1
v_add_f32_dpp v11, v27, v13 row_ror:8 row_mask:0xf bank_mask:0x2
s_nop 1
v_add_f32_dpp v11, v31, v14 row_ror:12 row_mask:0xf bank_mask:0x4
s_nop 1
v_add_f32_dpp v11, v34, v15 row_ror:4 row_mask:0xf bank_mask:0x8
v_cvt_pk_bf16_f32 v12, v11, v11
v_lshlrev_b32 v12, 16, v12
v_mul_f32 v12, s72, v12
v_cvt_pk_bf16_f32 v12, v12, v12
v_lshlrev_b32 v12, 16, v12
v_max_f32 v8, v8, v12
ds_write_b32 v116, v12 offset:768
s_waitcnt vmcnt(36)
v_mfma_f32_16x16x32_bf16 v[20:23], a[16:19], v[4:7], 0
v_mfma_f32_16x16x32_bf16 v[24:27], a[20:23], v[4:7], 0
v_mfma_f32_16x16x32_bf16 v[28:31], a[24:27], v[4:7], 0
v_mfma_f32_16x16x32_bf16 v[32:35], a[28:31], v[4:7], 0
s_nop 4
v_add_f32_dpp v12, v21, v20 row_ror:12 row_mask:0xf bank_mask:0x1
v_add_f32_dpp v13, v24, v25 row_ror:4 row_mask:0xf bank_mask:0x2
v_add_f32_dpp v14, v28, v30 row_ror:8 row_mask:0xf bank_mask:0x4
v_add_f32_dpp v15, v32, v35 row_ror:12 row_mask:0xf bank_mask:0x8
v_add_f32_dpp v12, v22, v12 row_ror:8 row_mask:0xf bank_mask:0x1
v_add_f32_dpp v13, v26, v13 row_ror:12 row_mask:0xf bank_mask:0x2
v_add_f32_dpp v14, v29, v14 row_ror:4 row_mask:0xf bank_mask:0x4
v_add_f32_dpp v15, v33, v15 row_ror:8 row_mask:0xf bank_mask:0x8
v_add_f32_dpp v11, v23, v12 row_ror:4 row_mask:0xf bank_mask:0x1
s_nop 1
v_add_f32_dpp v11, v27, v13 row_ror:8 row_mask:0xf bank_mask:0x2
s_nop 1
v_add_f32_dpp v11, v31, v14 row_ror:12 row_mask:0xf bank_mask:0x4
s_nop 1
v_add_f32_dpp v11, v34, v15 row_ror:4 row_mask:0xf bank_mask:0x8
v_cvt_pk_bf16_f32 v12, v11, v11
v_lshlrev_b32 v12, 16, v12
v_mul_f32 v12, s72, v12
v_cvt_pk_bf16_f32 v12, v12, v12
v_lshlrev_b32 v12, 16, v12
v_max_f32 v8, v8, v12
ds_write_b32 v116, v12 offset:1024
s_waitcnt vmcnt(32)
v_mfma_f32_16x16x32_bf16 v[20:23], a[80:83], v[4:7], 0
v_mfma_f32_16x16x32_bf16 v[24:27], a[84:87], v[4:7], 0
v_mfma_f32_16x16x32_bf16 v[28:31], a[88:91], v[4:7], 0
v_mfma_f32_16x16x32_bf16 v[32:35], a[92:95], v[4:7], 0
s_nop 4
v_add_f32_dpp v12, v21, v20 row_ror:12 row_mask:0xf bank_mask:0x1
v_add_f32_dpp v13, v24, v25 row_ror:4 row_mask:0xf bank_mask:0x2
v_add_f32_dpp v14, v28, v30 row_ror:8 row_mask:0xf bank_mask:0x4
v_add_f32_dpp v15, v32, v35 row_ror:12 row_mask:0xf bank_mask:0x8
v_add_f32_dpp v12, v22, v12 row_ror:8 row_mask:0xf bank_mask:0x1
v_add_f32_dpp v13, v26, v13 row_ror:12 row_mask:0xf bank_mask:0x2
v_add_f32_dpp v14, v29, v14 row_ror:4 row_mask:0xf bank_mask:0x4
v_add_f32_dpp v15, v33, v15 row_ror:8 row_mask:0xf bank_mask:0x8
v_add_f32_dpp v11, v23, v12 row_ror:4 row_mask:0xf bank_mask:0x1
s_nop 1
v_add_f32_dpp v11, v27, v13 row_ror:8 row_mask:0xf bank_mask:0x2
s_nop 1
v_add_f32_dpp v11, v31, v14 row_ror:12 row_mask:0xf bank_mask:0x4
s_nop 1
v_add_f32_dpp v11, v34, v15 row_ror:4 row_mask:0xf bank_mask:0x8
v_cvt_pk_bf16_f32 v12, v11, v11
v_lshlrev_b32 v12, 16, v12
v_mul_f32 v12, s72, v12
v_cvt_pk_bf16_f32 v12, v12, v12
v_lshlrev_b32 v12, 16, v12
v_max_f32 v8, v8, v12
ds_write_b32 v116, v12 offset:1280
s_waitcnt vmcnt(28)
v_mfma_f32_16x16x32_bf16 v[20:23], a[96:99], v[4:7], 0
v_mfma_f32_16x16x32_bf16 v[24:27], a[100:103], v[4:7], 0
v_mfma_f32_16x16x32_bf16 v[28:31], a[104:107], v[4:7], 0
v_mfma_f32_16x16x32_bf16 v[32:35], a[108:111], v[4:7], 0
s_add_u32 s30, s30, 49152
s_waitcnt vmcnt(4)
buffer_load_dwordx4 a[48:51], v1, s[8:11], s30 offen offset:0 nt
buffer_load_dwordx4 a[52:55], v1, s[8:11], s30 offen offset:1024 nt
buffer_load_dwordx4 a[56:59], v1, s[8:11], s30 offen offset:2048 nt
buffer_load_dwordx4 a[60:63], v1, s[8:11], s30 offen offset:3072 nt
v_add_f32_dpp v12, v21, v20 row_ror:12 row_mask:0xf bank_mask:0x1
v_add_f32_dpp v13, v24, v25 row_ror:4 row_mask:0xf bank_mask:0x2
v_add_f32_dpp v14, v28, v30 row_ror:8 row_mask:0xf bank_mask:0x4
v_add_f32_dpp v15, v32, v35 row_ror:12 row_mask:0xf bank_mask:0x8
v_add_f32_dpp v12, v22, v12 row_ror:8 row_mask:0xf bank_mask:0x1
v_add_f32_dpp v13, v26, v13 row_ror:12 row_mask:0xf bank_mask:0x2
v_add_f32_dpp v14, v29, v14 row_ror:4 row_mask:0xf bank_mask:0x4
v_add_f32_dpp v15, v33, v15 row_ror:8 row_mask:0xf bank_mask:0x8
v_add_f32_dpp v11, v23, v12 row_ror:4 row_mask:0xf bank_mask:0x1
s_nop 1
v_add_f32_dpp v11, v27, v13 row_ror:8 row_mask:0xf bank_mask:0x2
s_nop 1
v_add_f32_dpp v11, v31, v14 row_ror:12 row_mask:0xf bank_mask:0x4
s_nop 1
v_add_f32_dpp v11, v34, v15 row_ror:4 row_mask:0xf bank_mask:0x8
v_cvt_pk_bf16_f32 v12, v11, v11
v_lshlrev_b32 v12, 16, v12
v_mul_f32 v12, s72, v12
v_cvt_pk_bf16_f32 v12, v12, v12
v_lshlrev_b32 v12, 16, v12
v_max_f32 v8, v8, v12
ds_write_b32 v116, v12 offset:1536
s_waitcnt vmcnt(28)
v_mfma_f32_16x16x32_bf16 v[20:23], a[112:115], v[4:7], 0
v_mfma_f32_16x16x32_bf16 v[24:27], a[116:119], v[4:7], 0
v_mfma_f32_16x16x32_bf16 v[28:31], a[120:123], v[4:7], 0
v_mfma_f32_16x16x32_bf16 v[32:35], a[124:127], v[4:7], 0
s_nop 4
v_add_f32_dpp v12, v21, v20 row_ror:12 row_mask:0xf bank_mask:0x1
v_add_f32_dpp v13, v24, v25 row_ror:4 row_mask:0xf bank_mask:0x2
v_add_f32_dpp v14, v28, v30 row_ror:8 row_mask:0xf bank_mask:0x4
v_add_f32_dpp v15, v32, v35 row_ror:12 row_mask:0xf bank_mask:0x8
v_add_f32_dpp v12, v22, v12 row_ror:8 row_mask:0xf bank_mask:0x1
v_add_f32_dpp v13, v26, v13 row_ror:12 row_mask:0xf bank_mask:0x2
v_add_f32_dpp v14, v29, v14 row_ror:4 row_mask:0xf bank_mask:0x4
v_add_f32_dpp v15, v33, v15 row_ror:8 row_mask:0xf bank_mask:0x8
v_add_f32_dpp v11, v23, v12 row_ror:4 row_mask:0xf bank_mask:0x1
s_nop 1
v_add_f32_dpp v11, v27, v13 row_ror:8 row_mask:0xf bank_mask:0x2
s_nop 1
v_add_f32_dpp v11, v31, v14 row_ror:12 row_mask:0xf bank_mask:0x4
s_nop 1
v_add_f32_dpp v11, v34, v15 row_ror:4 row_mask:0xf bank_mask:0x8
v_cvt_pk_bf16_f32 v12, v11, v11
v_lshlrev_b32 v12, 16, v12
v_mul_f32 v12, s72, v12
v_cvt_pk_bf16_f32 v12, v12, v12
v_lshlrev_b32 v12, 16, v12
v_max_f32 v8, v8, v12
ds_write_b32 v116, v12 offset:1792
s_waitcnt vmcnt(24)
v_mfma_f32_16x16x32_bf16 v[20:23], a[128:131], v[4:7], 0
v_mfma_f32_16x16x32_bf16 v[24:27], a[132:135], v[4:7], 0
v_mfma_f32_16x16x32_bf16 v[28:31], a[136:139], v[4:7], 0
v_mfma_f32_16x16x32_bf16 v[32:35], a[140:143], v[4:7], 0
s_nop 4
v_add_f32_dpp v12, v21, v20 row_ror:12 row_mask:0xf bank_mask:0x1
v_add_f32_dpp v13, v24, v25 row_ror:4 row_mask:0xf bank_mask:0x2
v_add_f32_dpp v14, v28, v30 row_ror:8 row_mask:0xf bank_mask:0x4
v_add_f32_dpp v15, v32, v35 row_ror:12 row_mask:0xf bank_mask:0x8
v_add_f32_dpp v12, v22, v12 row_ror:8 row_mask:0xf bank_mask:0x1
v_add_f32_dpp v13, v26, v13 row_ror:12 row_mask:0xf bank_mask:0x2
v_add_f32_dpp v14, v29, v14 row_ror:4 row_mask:0xf bank_mask:0x4
v_add_f32_dpp v15, v33, v15 row_ror:8 row_mask:0xf bank_mask:0x8
v_add_f32_dpp v11, v23, v12 row_ror:4 row_mask:0xf bank_mask:0x1
s_nop 1
v_add_f32_dpp v11, v27, v13 row_ror:8 row_mask:0xf bank_mask:0x2
s_nop 1
v_add_f32_dpp v11, v31, v14 row_ror:12 row_mask:0xf bank_mask:0x4
s_nop 1
v_add_f32_dpp v11, v34, v15 row_ror:4 row_mask:0xf bank_mask:0x8
v_cvt_pk_bf16_f32 v12, v11, v11
v_lshlrev_b32 v12, 16, v12
v_mul_f32 v12, s72, v12
v_cvt_pk_bf16_f32 v12, v12, v12
v_lshlrev_b32 v12, 16, v12
v_max_f32 v8, v8, v12
ds_write_b32 v116, v12 offset:2048
s_waitcnt vmcnt(20)
v_mfma_f32_16x16x32_bf16 v[20:23], a[144:147], v[4:7], 0
v_mfma_f32_16x16x32_bf16 v[24:27], a[148:151], v[4:7], 0
v_mfma_f32_16x16x32_bf16 v[28:31], a[152:155], v[4:7], 0
v_mfma_f32_16x16x32_bf16 v[32:35], a[156:159], v[4:7], 0
s_add_u32 s30, s30, 49152
s_waitcnt vmcnt(4)
buffer_load_dwordx4 a[64:67], v1, s[8:11], s30 offen offset:0 nt
buffer_load_dwordx4 a[68:71], v1, s[8:11], s30 offen offset:1024 nt
buffer_load_dwordx4 a[72:75], v1, s[8:11], s30 offen offset:2048 nt
buffer_load_dwordx4 a[76:79], v1, s[8:11], s30 offen offset:3072 nt
v_add_f32_dpp v12, v21, v20 row_ror:12 row_mask:0xf bank_mask:0x1
v_add_f32_dpp v13, v24, v25 row_ror:4 row_mask:0xf bank_mask:0x2
v_add_f32_dpp v14, v28, v30 row_ror:8 row_mask:0xf bank_mask:0x4
v_add_f32_dpp v15, v32, v35 row_ror:12 row_mask:0xf bank_mask:0x8
v_add_f32_dpp v12, v22, v12 row_ror:8 row_mask:0xf bank_mask:0x1
v_add_f32_dpp v13, v26, v13 row_ror:12 row_mask:0xf bank_mask:0x2
v_add_f32_dpp v14, v29, v14 row_ror:4 row_mask:0xf bank_mask:0x4
v_add_f32_dpp v15, v33, v15 row_ror:8 row_mask:0xf bank_mask:0x8
v_add_f32_dpp v11, v23, v12 row_ror:4 row_mask:0xf bank_mask:0x1
s_nop 1
v_add_f32_dpp v11, v27, v13 row_ror:8 row_mask:0xf bank_mask:0x2
s_nop 1
v_add_f32_dpp v11, v31, v14 row_ror:12 row_mask:0xf bank_mask:0x4
s_nop 1
v_add_f32_dpp v11, v34, v15 row_ror:4 row_mask:0xf bank_mask:0x8
v_cvt_pk_bf16_f32 v12, v11, v11
v_lshlrev_b32 v12, 16, v12
v_mul_f32 v12, s72, v12
v_cvt_pk_bf16_f32 v12, v12, v12
v_lshlrev_b32 v12, 16, v12
v_max_f32 v8, v8, v12
ds_write_b32 v116, v12 offset:2304
s_waitcnt vmcnt(20)
v_mfma_f32_16x16x32_bf16 v[20:23], a[160:163], v[4:7], 0
v_mfma_f32_16x16x32_bf16 v[24:27], a[164:167], v[4:7], 0
v_mfma_f32_16x16x32_bf16 v[28:31], a[168:171], v[4:7], 0
v_mfma_f32_16x16x32_bf16 v[32:35], a[172:175], v[4:7], 0
s_nop 4
v_add_f32_dpp v12, v21, v20 row_ror:12 row_mask:0xf bank_mask:0x1
v_add_f32_dpp v13, v24, v25 row_ror:4 row_mask:0xf bank_mask:0x2
v_add_f32_dpp v14, v28, v30 row_ror:8 row_mask:0xf bank_mask:0x4
v_add_f32_dpp v15, v32, v35 row_ror:12 row_mask:0xf bank_mask:0x8
v_add_f32_dpp v12, v22, v12 row_ror:8 row_mask:0xf bank_mask:0x1
v_add_f32_dpp v13, v26, v13 row_ror:12 row_mask:0xf bank_mask:0x2
v_add_f32_dpp v14, v29, v14 row_ror:4 row_mask:0xf bank_mask:0x4
v_add_f32_dpp v15, v33, v15 row_ror:8 row_mask:0xf bank_mask:0x8
v_add_f32_dpp v11, v23, v12 row_ror:4 row_mask:0xf bank_mask:0x1
s_nop 1
v_add_f32_dpp v11, v27, v13 row_ror:8 row_mask:0xf bank_mask:0x2
s_nop 1
v_add_f32_dpp v11, v31, v14 row_ror:12 row_mask:0xf bank_mask:0x4
s_nop 1
v_add_f32_dpp v11, v34, v15 row_ror:4 row_mask:0xf bank_mask:0x8
v_cvt_pk_bf16_f32 v12, v11, v11
v_lshlrev_b32 v12, 16, v12
v_mul_f32 v12, s72, v12
v_cvt_pk_bf16_f32 v12, v12, v12
v_lshlrev_b32 v12, 16, v12
v_max_f32 v8, v8, v12
ds_write_b32 v116, v12 offset:2560
s_waitcnt vmcnt(16)
v_mfma_f32_16x16x32_bf16 v[20:23], a[176:179], v[4:7], 0
v_mfma_f32_16x16x32_bf16 v[24:27], a[180:183], v[4:7], 0
v_mfma_f32_16x16x32_bf16 v[28:31], a[184:187], v[4:7], 0
v_mfma_f32_16x16x32_bf16 v[32:35], a[188:191], v[4:7], 0
s_nop 4
v_add_f32_dpp v12, v21, v20 row_ror:12 row_mask:0xf bank_mask:0x1
v_add_f32_dpp v13, v24, v25 row_ror:4 row_mask:0xf bank_mask:0x2
v_add_f32_dpp v14, v28, v30 row_ror:8 row_mask:0xf bank_mask:0x4
v_add_f32_dpp v15, v32, v35 row_ror:12 row_mask:0xf bank_mask:0x8
v_add_f32_dpp v12, v22, v12 row_ror:8 row_mask:0xf bank_mask:0x1
v_add_f32_dpp v13, v26, v13 row_ror:12 row_mask:0xf bank_mask:0x2
v_add_f32_dpp v14, v29, v14 row_ror:4 row_mask:0xf bank_mask:0x4
v_add_f32_dpp v15, v33, v15 row_ror:8 row_mask:0xf bank_mask:0x8
v_add_f32_dpp v11, v23, v12 row_ror:4 row_mask:0xf bank_mask:0x1
s_nop 1
v_add_f32_dpp v11, v27, v13 row_ror:8 row_mask:0xf bank_mask:0x2
s_nop 1
v_add_f32_dpp v11, v31, v14 row_ror:12 row_mask:0xf bank_mask:0x4
s_nop 1
v_add_f32_dpp v11, v34, v15 row_ror:4 row_mask:0xf bank_mask:0x8
v_cvt_pk_bf16_f32 v12, v11, v11
v_lshlrev_b32 v12, 16, v12
v_mul_f32 v12, s72, v12
v_cvt_pk_bf16_f32 v12, v12, v12
v_lshlrev_b32 v12, 16, v12
v_max_f32 v8, v8, v12
ds_write_b32 v116, v12 offset:2816
s_waitcnt vmcnt(12)
v_mfma_f32_16x16x32_bf16 v[20:23], a[192:195], v[4:7], 0
v_mfma_f32_16x16x32_bf16 v[24:27], a[196:199], v[4:7], 0
v_mfma_f32_16x16x32_bf16 v[28:31], a[200:203], v[4:7], 0
v_mfma_f32_16x16x32_bf16 v[32:35], a[204:207], v[4:7], 0
s_add_u32 s30, s30, 49152
s_waitcnt vmcnt(4)
buffer_load_dwordx4 a[0:3], v1, s[8:11], s30 offen offset:0 nt
buffer_load_dwordx4 a[4:7], v1, s[8:11], s30 offen offset:1024 nt
buffer_load_dwordx4 a[8:11], v1, s[8:11], s30 offen offset:2048 nt
buffer_load_dwordx4 a[12:15], v1, s[8:11], s30 offen offset:3072 nt
v_add_f32_dpp v12, v21, v20 row_ror:12 row_mask:0xf bank_mask:0x1
v_add_f32_dpp v13, v24, v25 row_ror:4 row_mask:0xf bank_mask:0x2
v_add_f32_dpp v14, v28, v30 row_ror:8 row_mask:0xf bank_mask:0x4
v_add_f32_dpp v15, v32, v35 row_ror:12 row_mask:0xf bank_mask:0x8
v_add_f32_dpp v12, v22, v12 row_ror:8 row_mask:0xf bank_mask:0x1
v_add_f32_dpp v13, v26, v13 row_ror:12 row_mask:0xf bank_mask:0x2
v_add_f32_dpp v14, v29, v14 row_ror:4 row_mask:0xf bank_mask:0x4
v_add_f32_dpp v15, v33, v15 row_ror:8 row_mask:0xf bank_mask:0x8
v_add_f32_dpp v11, v23, v12 row_ror:4 row_mask:0xf bank_mask:0x1
s_nop 1
v_add_f32_dpp v11, v27, v13 row_ror:8 row_mask:0xf bank_mask:0x2
s_nop 1
v_add_f32_dpp v11, v31, v14 row_ror:12 row_mask:0xf bank_mask:0x4
s_nop 1
v_add_f32_dpp v11, v34, v15 row_ror:4 row_mask:0xf bank_mask:0x8
v_cvt_pk_bf16_f32 v12, v11, v11
v_lshlrev_b32 v12, 16, v12
v_mul_f32 v12, s72, v12
v_cvt_pk_bf16_f32 v12, v12, v12
v_lshlrev_b32 v12, 16, v12
v_max_f32 v8, v8, v12
ds_write_b32 v116, v12 offset:3072
s_waitcnt vmcnt(12)
v_mfma_f32_16x16x32_bf16 v[20:23], a[32:35], v[4:7], 0
v_mfma_f32_16x16x32_bf16 v[24:27], a[36:39], v[4:7], 0
v_mfma_f32_16x16x32_bf16 v[28:31], a[40:43], v[4:7], 0
v_mfma_f32_16x16x32_bf16 v[32:35], a[44:47], v[4:7], 0
s_nop 4
v_add_f32_dpp v12, v21, v20 row_ror:12 row_mask:0xf bank_mask:0x1
v_add_f32_dpp v13, v24, v25 row_ror:4 row_mask:0xf bank_mask:0x2
v_add_f32_dpp v14, v28, v30 row_ror:8 row_mask:0xf bank_mask:0x4
v_add_f32_dpp v15, v32, v35 row_ror:12 row_mask:0xf bank_mask:0x8
v_add_f32_dpp v12, v22, v12 row_ror:8 row_mask:0xf bank_mask:0x1
v_add_f32_dpp v13, v26, v13 row_ror:12 row_mask:0xf bank_mask:0x2
v_add_f32_dpp v14, v29, v14 row_ror:4 row_mask:0xf bank_mask:0x4
v_add_f32_dpp v15, v33, v15 row_ror:8 row_mask:0xf bank_mask:0x8
v_add_f32_dpp v11, v23, v12 row_ror:4 row_mask:0xf bank_mask:0x1
s_nop 1
v_add_f32_dpp v11, v27, v13 row_ror:8 row_mask:0xf bank_mask:0x2
s_nop 1
v_add_f32_dpp v11, v31, v14 row_ror:12 row_mask:0xf bank_mask:0x4
s_nop 1
v_add_f32_dpp v11, v34, v15 row_ror:4 row_mask:0xf bank_mask:0x8
v_cvt_pk_bf16_f32 v12, v11, v11
v_lshlrev_b32 v12, 16, v12
v_mul_f32 v12, s72, v12
v_cvt_pk_bf16_f32 v12, v12, v12
v_lshlrev_b32 v12, 16, v12
v_max_f32 v8, v8, v12
ds_write_b32 v116, v12 offset:3328
s_waitcnt vmcnt(8)
v_mfma_f32_16x16x32_bf16 v[20:23], a[48:51], v[4:7], 0
v_mfma_f32_16x16x32_bf16 v[24:27], a[52:55], v[4:7], 0
v_mfma_f32_16x16x32_bf16 v[28:31], a[56:59], v[4:7], 0
v_mfma_f32_16x16x32_bf16 v[32:35], a[60:63], v[4:7], 0
s_nop 4
v_add_f32_dpp v12, v21, v20 row_ror:12 row_mask:0xf bank_mask:0x1
v_add_f32_dpp v13, v24, v25 row_ror:4 row_mask:0xf bank_mask:0x2
v_add_f32_dpp v14, v28, v30 row_ror:8 row_mask:0xf bank_mask:0x4
v_add_f32_dpp v15, v32, v35 row_ror:12 row_mask:0xf bank_mask:0x8
v_add_f32_dpp v12, v22, v12 row_ror:8 row_mask:0xf bank_mask:0x1
v_add_f32_dpp v13, v26, v13 row_ror:12 row_mask:0xf bank_mask:0x2
v_add_f32_dpp v14, v29, v14 row_ror:4 row_mask:0xf bank_mask:0x4
v_add_f32_dpp v15, v33, v15 row_ror:8 row_mask:0xf bank_mask:0x8
v_add_f32_dpp v11, v23, v12 row_ror:4 row_mask:0xf bank_mask:0x1
s_nop 1
v_add_f32_dpp v11, v27, v13 row_ror:8 row_mask:0xf bank_mask:0x2
s_nop 1
v_add_f32_dpp v11, v31, v14 row_ror:12 row_mask:0xf bank_mask:0x4
s_nop 1
v_add_f32_dpp v11, v34, v15 row_ror:4 row_mask:0xf bank_mask:0x8
v_cvt_pk_bf16_f32 v12, v11, v11
v_lshlrev_b32 v12, 16, v12
v_mul_f32 v12, s72, v12
v_cvt_pk_bf16_f32 v12, v12, v12
v_lshlrev_b32 v12, 16, v12
v_max_f32 v8, v8, v12
ds_write_b32 v116, v12 offset:3584
s_waitcnt vmcnt(4)
v_mfma_f32_16x16x32_bf16 v[20:23], a[64:67], v[4:7], 0
v_mfma_f32_16x16x32_bf16 v[24:27], a[68:71], v[4:7], 0
v_mfma_f32_16x16x32_bf16 v[28:31], a[72:75], v[4:7], 0
v_mfma_f32_16x16x32_bf16 v[32:35], a[76:79], v[4:7], 0
s_add_u32 s30, s30, 49152
s_waitcnt vmcnt(4)
buffer_load_dwordx4 a[16:19], v1, s[8:11], s30 offen offset:0 nt
buffer_load_dwordx4 a[20:23], v1, s[8:11], s30 offen offset:1024 nt
buffer_load_dwordx4 a[24:27], v1, s[8:11], s30 offen offset:2048 nt
buffer_load_dwordx4 a[28:31], v1, s[8:11], s30 offen offset:3072 nt
v_add_f32_dpp v12, v21, v20 row_ror:12 row_mask:0xf bank_mask:0x1
v_add_f32_dpp v13, v24, v25 row_ror:4 row_mask:0xf bank_mask:0x2
v_add_f32_dpp v14, v28, v30 row_ror:8 row_mask:0xf bank_mask:0x4
v_add_f32_dpp v15, v32, v35 row_ror:12 row_mask:0xf bank_mask:0x8
v_add_f32_dpp v12, v22, v12 row_ror:8 row_mask:0xf bank_mask:0x1
v_add_f32_dpp v13, v26, v13 row_ror:12 row_mask:0xf bank_mask:0x2
v_add_f32_dpp v14, v29, v14 row_ror:4 row_mask:0xf bank_mask:0x4
v_add_f32_dpp v15, v33, v15 row_ror:8 row_mask:0xf bank_mask:0x8
v_add_f32_dpp v11, v23, v12 row_ror:4 row_mask:0xf bank_mask:0x1
s_nop 1
v_add_f32_dpp v11, v27, v13 row_ror:8 row_mask:0xf bank_mask:0x2
s_nop 1
v_add_f32_dpp v11, v31, v14 row_ror:12 row_mask:0xf bank_mask:0x4
s_nop 1
v_add_f32_dpp v11, v34, v15 row_ror:4 row_mask:0xf bank_mask:0x8
v_cvt_pk_bf16_f32 v12, v11, v11
v_lshlrev_b32 v12, 16, v12
v_mul_f32 v12, s72, v12
v_cvt_pk_bf16_f32 v12, v12, v12
v_lshlrev_b32 v12, 16, v12
v_max_f32 v8, v8, v12
ds_write_b32 v116, v12 offset:3840
v_add_u32 v116, 4096, v116
s_mov_b32 s60, 10
L_kloop:
s_waitcnt vmcnt(4)
v_mfma_f32_16x16x32_bf16 v[20:23], a[0:3], v[4:7], 0
v_mfma_f32_16x16x32_bf16 v[24:27], a[4:7], v[4:7], 0
v_mfma_f32_16x16x32_bf16 v[28:31], a[8:11], v[4:7], 0
v_mfma_f32_16x16x32_bf16 v[32:35], a[12:15], v[4:7], 0
s_add_u32 s30, s30, 49152
buffer_load_dwordx4 a[0:3], v1, s[8:11], s30 offen offset:0 nt
buffer_load_dwordx4 a[4:7], v1, s[8:11], s30 offen offset:1024 nt
buffer_load_dwordx4 a[8:11], v1, s[8:11], s30 offen offset:2048 nt
buffer_load_dwordx4 a[12:15], v1, s[8:11], s30 offen offset:3072 nt
v_add_f32_dpp v12, v21, v20 row_ror:12 row_mask:0xf bank_mask:0x1
v_add_f32_dpp v13, v24, v25 row_ror:4 row_mask:0xf bank_mask:0x2
v_add_f32_dpp v14, v28, v30 row_ror:8 row_mask:0xf bank_mask:0x4
v_add_f32_dpp v15, v32, v35 row_ror:12 row_mask:0xf bank_mask:0x8
v_add_f32_dpp v12, v22, v12 row_ror:8 row_mask:0xf bank_mask:0x1
v_add_f32_dpp v13, v26, v13 row_ror:12 row_mask:0xf bank_mask:0x2
v_add_f32_dpp v14, v29, v14 row_ror:4 row_mask:0xf bank_mask:0x4
v_add_f32_dpp v15, v33, v15 row_ror:8 row_mask:0xf bank_mask:0x8
v_add_f32_dpp v11, v23, v12 row_ror:4 row_mask:0xf bank_mask:0x1
s_nop 1
v_add_f32_dpp v11, v27, v13 row_ror:8 row_mask:0xf bank_mask:0x2
s_nop 1
v_add_f32_dpp v11, v31, v14 row_ror:12 row_mask:0xf bank_mask:0x4
s_nop 1
v_add_f32_dpp v11, v34, v15 row_ror:4 row_mask:0xf bank_mask:0x8
v_cvt_pk_bf16_f32 v12, v11, v11
v_lshlrev_b32 v12, 16, v12
v_mul_f32 v12, s72, v12
v_cvt_pk_bf16_f32 v12, v12, v12
v_lshlrev_b32 v12, 16, v12
v_max_f32 v8, v8, v12
ds_write_b32 v116, v12 offset:0
s_waitcnt vmcnt(4)
v_mfma_f32_16x16x32_bf16 v[20:23], a[16:19], v[4:7], 0
v_mfma_f32_16x16x32_bf16 v[24:27], a[20:23], v[4:7], 0
v_mfma_f32_16x16x32_bf16 v[28:31], a[24:27], v[4:7], 0
v_mfma_f32_16x16x32_bf16 v[32:35], a[28:31], v[4:7], 0
s_add_u32 s30, s30, 49152
buffer_load_dwordx4 a[16:19], v1, s[8:11], s30 offen offset:0 nt
buffer_load_dwordx4 a[20:23], v1, s[8:11], s30 offen offset:1024 nt
buffer_load_dwordx4 a[24:27], v1, s[8:11], s30 offen offset:2048 nt
buffer_load_dwordx4 a[28:31], v1, s[8:11], s30 offen offset:3072 nt
v_add_f32_dpp v12, v21, v20 row_ror:12 row_mask:0xf bank_mask:0x1
v_add_f32_dpp v13, v24, v25 row_ror:4 row_mask:0xf bank_mask:0x2
v_add_f32_dpp v14, v28, v30 row_ror:8 row_mask:0xf bank_mask:0x4
v_add_f32_dpp v15, v32, v35 row_ror:12 row_mask:0xf bank_mask:0x8
v_add_f32_dpp v12, v22, v12 row_ror:8 row_mask:0xf bank_mask:0x1
v_add_f32_dpp v13, v26, v13 row_ror:12 row_mask:0xf bank_mask:0x2
v_add_f32_dpp v14, v29, v14 row_ror:4 row_mask:0xf bank_mask:0x4
v_add_f32_dpp v15, v33, v15 row_ror:8 row_mask:0xf bank_mask:0x8
v_add_f32_dpp v11, v23, v12 row_ror:4 row_mask:0xf bank_mask:0x1
s_nop 1
v_add_f32_dpp v11, v27, v13 row_ror:8 row_mask:0xf bank_mask:0x2
s_nop 1
v_add_f32_dpp v11, v31, v14 row_ror:12 row_mask:0xf bank_mask:0x4
s_nop 1
v_add_f32_dpp v11, v34, v15 row_ror:4 row_mask:0xf bank_mask:0x8
v_cvt_pk_bf16_f32 v12, v11, v11
v_lshlrev_b32 v12, 16, v12
v_mul_f32 v12, s72, v12
v_cvt_pk_bf16_f32 v12, v12, v12
v_lshlrev_b32 v12, 16, v12
v_max_f32 v8, v8, v12
ds_write_b32 v116, v12 offset:256
v_add_u32 v116, 512, v116
s_sub_u32 s60, s60, 1
s_cmp_lg_u32 s60, 0
s_cbranch_scc1 L_kloop
s_waitcnt vmcnt(4)
s_mov_b32 s30, s58
buffer_load_dwordx4 v[84:87], v2, s[12:15], s30 offen offset:0 nt
buffer_load_dwordx4 v[88:91], v2, s[12:15], s30 offen offset:1024 nt
buffer_load_dwordx4 v[92:95], v2, s[12:15], s30 offen offset:2048 nt
buffer_load_dwordx4 v[96:99], v2, s[12:15], s30 offen offset:3072 nt
v_mfma_f32_16x16x32_bf16 v[20:23], a[0:3], v[4:7], 0
v_mfma_f32_16x16x32_bf16 v[24:27], a[4:7], v[4:7], 0
v_mfma_f32_16x16x32_bf16 v[28:31], a[8:11], v[4:7], 0
v_mfma_f32_16x16x32_bf16 v[32:35], a[12:15], v[4:7], 0
s_nop 4
v_add_f32_dpp v12, v21, v20 row_ror:12 row_mask:0xf bank_mask:0x1
v_add_f32_dpp v13, v24, v25 row_ror:4 row_mask:0xf bank_mask:0x2
v_add_f32_dpp v14, v28, v30 row_ror:8 row_mask:0xf bank_mask:0x4
v_add_f32_dpp v15, v32, v35 row_ror:12 row_mask:0xf bank_mask:0x8
v_add_f32_dpp v12, v22, v12 row_ror:8 row_mask:0xf bank_mask:0x1
v_add_f32_dpp v13, v26, v13 row_ror:12 row_mask:0xf bank_mask:0x2
v_add_f32_dpp v14, v29, v14 row_ror:4 row_mask:0xf bank_mask:0x4
v_add_f32_dpp v15, v33, v15 row_ror:8 row_mask:0xf bank_mask:0x8
v_add_f32_dpp v11, v23, v12 row_ror:4 row_mask:0xf bank_mask:0x1
s_nop 1
v_add_f32_dpp v11, v27, v13 row_ror:8 row_mask:0xf bank_mask:0x2
s_nop 1
v_add_f32_dpp v11, v31, v14 row_ror:12 row_mask:0xf bank_mask:0x4
s_nop 1
v_add_f32_dpp v11, v34, v15 row_ror:4 row_mask:0xf bank_mask:0x8
v_cvt_pk_bf16_f32 v12, v11, v11
v_lshlrev_b32 v12, 16, v12
v_mul_f32 v12, s72, v12
v_cvt_pk_bf16_f32 v12, v12, v12
v_lshlrev_b32 v12, 16, v12
v_max_f32 v8, v8, v12
ds_write_b32 v116, v12 offset:0
s_waitcnt vmcnt(4)
s_add_u32 s30, s30, 49152
buffer_load_dwordx4 v[100:103], v2, s[12:15], s30 offen offset:0 nt
buffer_load_dwordx4 v[104:107], v2, s[12:15], s30 offen offset:1024 nt
buffer_load_dwordx4 v[108:111], v2, s[12:15], s30 offen offset:2048 nt
buffer_load_dwordx4 v[112:115], v2, s[12:15], s30 offen offset:3072 nt
v_mfma_f32_16x16x32_bf16 v[20:23], a[16:19], v[4:7], 0
v_mfma_f32_16x16x32_bf16 v[24:27], a[20:23], v[4:7], 0
v_mfma_f32_16x16x32_bf16 v[28:31], a[24:27], v[4:7], 0
v_mfma_f32_16x16x32_bf16 v[32:35], a[28:31], v[4:7], 0
s_nop 4
v_add_f32_dpp v12, v21, v20 row_ror:12 row_mask:0xf bank_mask:0x1
v_add_f32_dpp v13, v24, v25 row_ror:4 row_mask:0xf bank_mask:0x2
v_add_f32_dpp v14, v28, v30 row_ror:8 row_mask:0xf bank_mask:0x4
v_add_f32_dpp v15, v32, v35 row_ror:12 row_mask:0xf bank_mask:0x8
v_add_f32_dpp v12, v22, v12 row_ror:8 row_mask:0xf bank_mask:0x1
v_add_f32_dpp v13, v26, v13 row_ror:12 row_mask:0xf bank_mask:0x2
v_add_f32_dpp v14, v29, v14 row_ror:4 row_mask:0xf bank_mask:0x4
v_add_f32_dpp v15, v33, v15 row_ror:8 row_mask:0xf bank_mask:0x8
v_add_f32_dpp v11, v23, v12 row_ror:4 row_mask:0xf bank_mask:0x1
s_nop 1
v_add_f32_dpp v11, v27, v13 row_ror:8 row_mask:0xf bank_mask:0x2
s_nop 1
v_add_f32_dpp v11, v31, v14 row_ror:12 row_mask:0xf bank_mask:0x4
s_nop 1
v_add_f32_dpp v11, v34, v15 row_ror:4 row_mask:0xf bank_mask:0x8
v_cvt_pk_bf16_f32 v12, v11, v11
v_lshlrev_b32 v12, 16, v12
v_mul_f32 v12, s72, v12
v_cvt_pk_bf16_f32 v12, v12, v12
v_lshlrev_b32 v12, 16, v12
v_max_f32 v8, v8, v12
ds_write_b32 v116, v12 offset:256
v_subrev_u32 v116, 9216, v116
s_waitcnt lgkmcnt(0)
ds_read_b32 v117, v116
v_max_f32_dpp v8, v8, v8 row_ror:4 row_mask:0xf bank_mask:0xf
s_nop 1
v_max_f32_dpp v8, v8, v8 row_ror:8 row_mask:0xf bank_mask:0xf
v_mov_b32 v14, v8
s_nop 1
v_permlane16_swap_b32 v14, v8
v_max_f32 v8, v8, v14
v_mov_b32 v14, v8
s_nop 1
v_permlane32_swap_b32 v14, v8
v_max_f32 v8, v8, v14
v_mul_f32 v9, s73, v8
s_mov_b32 s60, 17
L_vloop:
s_waitcnt lgkmcnt(0)
v_fma_f32 v12, v117, s73, -v9
v_exp_f32 v12, v12
s_nop 0
v_add_f32 v10, v10, v12
v_mov_b32_dpp v13, v12 row_ror:12 row_mask:0xf bank_mask:0xf
v_cvt_pk_bf16_f32 v16, v12, v13
s_nop 1
v_mov_b32_dpp v17, v16 row_ror:8 row_mask:0xf bank_mask:0xf
ds_read_b32 v117, v116 offset:256
s_waitcnt vmcnt(4)
v_perm_b32 v36, v88, v84, s70
v_perm_b32 v38, v88, v84, s71
v_perm_b32 v40, v89, v85, s70
v_perm_b32 v42, v89, v85, s71
v_perm_b32 v44, v90, v86, s70
v_perm_b32 v46, v90, v86, s71
v_perm_b32 v48, v91, v87, s70
v_perm_b32 v50, v91, v87, s71
v_perm_b32 v37, v96, v92, s70
v_perm_b32 v39, v96, v92, s71
v_perm_b32 v41, v97, v93, s70
v_perm_b32 v43, v97, v93, s71
v_perm_b32 v45, v98, v94, s70
v_perm_b32 v47, v98, v94, s71
v_perm_b32 v49, v99, v95, s70
v_perm_b32 v51, v99, v95, s71
s_add_u32 s30, s30, 49152
buffer_load_dwordx4 v[84:87], v2, s[12:15], s30 offen offset:0 nt
buffer_load_dwordx4 v[88:91], v2, s[12:15], s30 offen offset:1024 nt
buffer_load_dwordx4 v[92:95], v2, s[12:15], s30 offen offset:2048 nt
buffer_load_dwordx4 v[96:99], v2, s[12:15], s30 offen offset:3072 nt
v_mfma_f32_16x16x16_bf16 v[52:55], v[36:37], v[16:17], v[52:55]
v_mfma_f32_16x16x16_bf16 v[56:59], v[38:39], v[16:17], v[56:59]
v_mfma_f32_16x16x16_bf16 v[60:63], v[40:41], v[16:17], v[60:63]
v_mfma_f32_16x16x16_bf16 v[64:67], v[42:43], v[16:17], v[64:67]
v_mfma_f32_16x16x16_bf16 v[68:71], v[44:45], v[16:17], v[68:71]
v_mfma_f32_16x16x16_bf16 v[72:75], v[46:47], v[16:17], v[72:75]
v_mfma_f32_16x16x16_bf16 v[76:79], v[48:49], v[16:17], v[76:79]
v_mfma_f32_16x16x16_bf16 v[80:83], v[50:51], v[16:17], v[80:83]
s_waitcnt lgkmcnt(0)
v_fma_f32 v12, v117, s73, -v9
v_exp_f32 v12, v12
s_nop 0
v_add_f32 v10, v10, v12
v_mov_b32_dpp v13, v12 row_ror:12 row_mask:0xf bank_mask:0xf
v_cvt_pk_bf16_f32 v16, v12, v13
s_nop 1
v_mov_b32_dpp v17, v16 row_ror:8 row_mask:0xf bank_mask:0xf
ds_read_b32 v117, v116 offset:512
s_waitcnt vmcnt(4)
v_perm_b32 v36, v104, v100, s70
v_perm_b32 v38, v104, v100, s71
v_perm_b32 v40, v105, v101, s70
v_perm_b32 v42, v105, v101, s71
v_perm_b32 v44, v106, v102, s70
v_perm_b32 v46, v106, v102, s71
v_perm_b32 v48, v107, v103, s70
v_perm_b32 v50, v107, v103, s71
v_perm_b32 v37, v112, v108, s70
v_perm_b32 v39, v112, v108, s71
v_perm_b32 v41, v113, v109, s70
v_perm_b32 v43, v113, v109, s71
v_perm_b32 v45, v114, v110, s70
v_perm_b32 v47, v114, v110, s71
v_perm_b32 v49, v115, v111, s70
v_perm_b32 v51, v115, v111, s71
s_add_u32 s30, s30, 49152
buffer_load_dwordx4 v[100:103], v2, s[12:15], s30 offen offset:0 nt
buffer_load_dwordx4 v[104:107], v2, s[12:15], s30 offen offset:1024 nt
buffer_load_dwordx4 v[108:111], v2, s[12:15], s30 offen offset:2048 nt
buffer_load_dwordx4 v[112:115], v2, s[12:15], s30 offen offset:3072 nt
v_mfma_f32_16x16x16_bf16 v[52:55], v[36:37], v[16:17], v[52:55]
v_mfma_f32_16x16x16_bf16 v[56:59], v[38:39], v[16:17], v[56:59]
v_mfma_f32_16x16x16_bf16 v[60:63], v[40:41], v[16:17], v[60:63]
v_mfma_f32_16x16x16_bf16 v[64:67], v[42:43], v[16:17], v[64:67]
v_mfma_f32_16x16x16_bf16 v[68:71], v[44:45], v[16:17], v[68:71]
v_mfma_f32_16x16x16_bf16 v[72:75], v[46:47], v[16:17], v[72:75]
v_mfma_f32_16x16x16_bf16 v[76:79], v[48:49], v[16:17], v[76:79]
v_mfma_f32_16x16x16_bf16 v[80:83], v[50:51], v[16:17], v[80:83]
v_add_u32 v116, 512, v116
s_sub_u32 s60, s60, 1
s_cmp_lg_u32 s60, 0
s_cbranch_scc1 L_vloop
ds_read_b32 v118, v116 offset:256
ds_read_b32 v119, v116 offset:512
ds_read_b32 v120, v116 offset:768
s_waitcnt lgkmcnt(0)
s_add_u32 s31, s31, 1
s_and_b32 s29, s31, 3
s_cmp_eq_u32 s61, 0
s_cselect_b32 s29, s55, s29
s_lshl_b32 s66, s29, 13
s_mov_b32 s86, 1
s_atomic_add s86, s[62:63], s66 glc
v_fma_f32 v12, v117, s73, -v9
v_exp_f32 v12, v12
s_nop 0
v_add_f32 v10, v10, v12
v_mov_b32_dpp v13, v12 row_ror:12 row_mask:0xf bank_mask:0xf
v_cvt_pk_bf16_f32 v16, v12, v13
s_nop 1
v_mov_b32_dpp v17, v16 row_ror:8 row_mask:0xf bank_mask:0xf
s_waitcnt vmcnt(4)
v_perm_b32 v36, v88, v84, s70
v_perm_b32 v38, v88, v84, s71
v_perm_b32 v40, v89, v85, s70
v_perm_b32 v42, v89, v85, s71
v_perm_b32 v44, v90, v86, s70
v_perm_b32 v46, v90, v86, s71
v_perm_b32 v48, v91, v87, s70
v_perm_b32 v50, v91, v87, s71
v_perm_b32 v37, v96, v92, s70
v_perm_b32 v39, v96, v92, s71
v_perm_b32 v41, v97, v93, s70
v_perm_b32 v43, v97, v93, s71
v_perm_b32 v45, v98, v94, s70
v_perm_b32 v47, v98, v94, s71
v_perm_b32 v49, v99, v95, s70
v_perm_b32 v51, v99, v95, s71
s_add_u32 s30, s30, 49152
buffer_load_dwordx4 v[84:87], v2, s[12:15], s30 offen offset:0 nt
buffer_load_dwordx4 v[88:91], v2, s[12:15], s30 offen offset:1024 nt
buffer_load_dwordx4 v[92:95], v2, s[12:15], s30 offen offset:2048 nt
buffer_load_dwordx4 v[96:99], v2, s[12:15], s30 offen offset:3072 nt
v_mfma_f32_16x16x16_bf16 v[52:55], v[36:37], v[16:17], v[52:55]
v_mfma_f32_16x16x16_bf16 v[56:59], v[38:39], v[16:17], v[56:59]
v_mfma_f32_16x16x16_bf16 v[60:63], v[40:41], v[16:17], v[60:63]
v_mfma_f32_16x16x16_bf16 v[64:67], v[42:43], v[16:17], v[64:67]
v_mfma_f32_16x16x16_bf16 v[68:71], v[44:45], v[16:17], v[68:71]
v_mfma_f32_16x16x16_bf16 v[72:75], v[46:47], v[16:17], v[72:75]
v_mfma_f32_16x16x16_bf16 v[76:79], v[48:49], v[16:17], v[76:79]
v_mfma_f32_16x16x16_bf16 v[80:83], v[50:51], v[16:17], v[80:83]
v_fma_f32 v12, v118, s73, -v9
v_exp_f32 v12, v12
s_nop 0
v_add_f32 v10, v10, v12
v_mov_b32_dpp v13, v12 row_ror:12 row_mask:0xf bank_mask:0xf
v_cvt_pk_bf16_f32 v16, v12, v13
s_nop 1
v_mov_b32_dpp v17, v16 row_ror:8 row_mask:0xf bank_mask:0xf
s_waitcnt vmcnt(4)
v_perm_b32 v36, v104, v100, s70
v_perm_b32 v38, v104, v100, s71
v_perm_b32 v40, v105, v101, s70
v_perm_b32 v42, v105, v101, s71
v_perm_b32 v44, v106, v102, s70
v_perm_b32 v46, v106, v102, s71
v_perm_b32 v48, v107, v103, s70
v_perm_b32 v50, v107, v103, s71
v_perm_b32 v37, v112, v108, s70
v_perm_b32 v39, v112, v108, s71
v_perm_b32 v41, v113, v109, s70
v_perm_b32 v43, v113, v109, s71
v_perm_b32 v45, v114, v110, s70
v_perm_b32 v47, v114, v110, s71
v_perm_b32 v49, v115, v111, s70
v_perm_b32 v51, v115, v111, s71
s_add_u32 s30, s30, 49152
buffer_load_dwordx4 v[100:103], v2, s[12:15], s30 offen offset:0 nt
buffer_load_dwordx4 v[104:107], v2, s[12:15], s30 offen offset:1024 nt
buffer_load_dwordx4 v[108:111], v2, s[12:15], s30 offen offset:2048 nt
buffer_load_dwordx4 v[112:115], v2, s[12:15], s30 offen offset:3072 nt
v_mfma_f32_16x16x16_bf16 v[52:55], v[36:37], v[16:17], v[52:55]
v_mfma_f32_16x16x16_bf16 v[56:59], v[38:39], v[16:17], v[56:59]
v_mfma_f32_16x16x16_bf16 v[60:63], v[40:41], v[16:17], v[60:63]
v_mfma_f32_16x16x16_bf16 v[64:67], v[42:43], v[16:17], v[64:67]
v_mfma_f32_16x16x16_bf16 v[68:71], v[44:45], v[16:17], v[68:71]
v_mfma_f32_16x16x16_bf16 v[72:75], v[46:47], v[16:17], v[72:75]
v_mfma_f32_16x16x16_bf16 v[76:79], v[48:49], v[16:17], v[76:79]
v_mfma_f32_16x16x16_bf16 v[80:83], v[50:51], v[16:17], v[80:83]
s_cmp_eq_u32 s29, s55
s_cbranch_scc1 L_rc0
s_waitcnt lgkmcnt(0)
s_cmp_lt_u32 s86, 112
s_cbranch_scc1 L_rc0
s_mov_b32 s61, 0
s_add_u32 s31, s31, 1
s_and_b32 s29, s31, 3
s_cmp_eq_u32 s61, 0
s_cselect_b32 s29, s55, s29
s_lshl_b32 s66, s29, 13
s_mov_b32 s86, 1
s_atomic_add s86, s[62:63], s66 glc
L_rc0:
v_fma_f32 v12, v119, s73, -v9
v_exp_f32 v12, v12
s_nop 0
v_add_f32 v10, v10, v12
v_mov_b32_dpp v13, v12 row_ror:12 row_mask:0xf bank_mask:0xf
v_cvt_pk_bf16_f32 v16, v12, v13
s_nop 1
v_mov_b32_dpp v17, v16 row_ror:8 row_mask:0xf bank_mask:0xf
s_waitcnt vmcnt(4)
v_perm_b32 v36, v88, v84, s70
v_perm_b32 v38, v88, v84, s71
v_perm_b32 v40, v89, v85, s70
v_perm_b32 v42, v89, v85, s71
v_perm_b32 v44, v90, v86, s70
v_perm_b32 v46, v90, v86, s71
v_perm_b32 v48, v91, v87, s70
v_perm_b32 v50, v91, v87, s71
v_perm_b32 v37, v96, v92, s70
v_perm_b32 v39, v96, v92, s71
v_perm_b32 v41, v97, v93, s70
v_perm_b32 v43, v97, v93, s71
v_perm_b32 v45, v98, v94, s70
v_perm_b32 v47, v98, v94, s71
v_perm_b32 v49, v99, v95, s70
v_perm_b32 v51, v99, v95, s71
s_waitcnt lgkmcnt(0)
s_add_u32 s66, s86, 912
s_cmp_lt_u32 s66, 998
s_cbranch_scc1 L_tk0
ds_write_b32 v18, v18
s_waitcnt lgkmcnt(0)
s_cmp_ge_u32 s66, 1024
s_cbranch_scc1 L_nodyn
L_tk0:
s_cmp_ge_u32 s66, 988
s_cselect_b32 s61, 0, s61
s_and_b32 s67, s66, 1
s_lshr_b32 s66, s66, 1
s_lshl_b32 s67, s67, 9
s_add_u32 s66, s66, s67
s_lshl_b32 s66, s66, 12
s_lshl_b32 s67, s29, 22
s_add_u32 s66, s66, s67
s_add_u32 s30, s28, s66
buffer_load_dwordx4 a[16:19], v1, s[8:11], s30 offen offset:0 nt
buffer_load_dwordx4 a[20:23], v1, s[8:11], s30 offen offset:1024 nt
buffer_load_dwordx4 a[24:27], v1, s[8:11], s30 offen offset:2048 nt
buffer_load_dwordx4 a[28:31], v1, s[8:11], s30 offen offset:3072 nt
s_add_u32 s31, s31, 1
s_and_b32 s29, s31, 3
s_cmp_eq_u32 s61, 0
s_cselect_b32 s29, s55, s29
s_lshl_b32 s66, s29, 13
s_mov_b32 s86, 1
s_atomic_add s86, s[62:63], s66 glc
v_mfma_f32_16x16x16_bf16 v[52:55], v[36:37], v[16:17], v[52:55]
v_mfma_f32_16x16x16_bf16 v[56:59], v[38:39], v[16:17], v[56:59]
v_mfma_f32_16x16x16_bf16 v[60:63], v[40:41], v[16:17], v[60:63]
v_mfma_f32_16x16x16_bf16 v[64:67], v[42:43], v[16:17], v[64:67]
v_mfma_f32_16x16x16_bf16 v[68:71], v[44:45], v[16:17], v[68:71]
v_mfma_f32_16x16x16_bf16 v[72:75], v[46:47], v[16:17], v[72:75]
v_mfma_f32_16x16x16_bf16 v[76:79], v[48:49], v[16:17], v[76:79]
v_mfma_f32_16x16x16_bf16 v[80:83], v[50:51], v[16:17], v[80:83]
v_fma_f32 v12, v120, s73, -v9
v_exp_f32 v12, v12
s_nop 0
v_add_f32 v10, v10, v12
v_mov_b32_dpp v13, v12 row_ror:12 row_mask:0xf bank_mask:0xf
v_cvt_pk_bf16_f32 v16, v12, v13
s_nop 1
v_mov_b32_dpp v17, v16 row_ror:8 row_mask:0xf bank_mask:0xf
s_waitcnt vmcnt(4)
v_perm_b32 v36, v104, v100, s70
v_perm_b32 v38, v104, v100, s71
v_perm_b32 v40, v105, v101, s70
v_perm_b32 v42, v105, v101, s71
v_perm_b32 v44, v106, v102, s70
v_perm_b32 v46, v106, v102, s71
v_perm_b32 v48, v107, v103, s70
v_perm_b32 v50, v107, v103, s71
v_perm_b32 v37, v112, v108, s70
v_perm_b32 v39, v112, v108, s71
v_perm_b32 v41, v113, v109, s70
v_perm_b32 v43, v113, v109, s71
v_perm_b32 v45, v114, v110, s70
v_perm_b32 v47, v114, v110, s71
v_perm_b32 v49, v115, v111, s70
v_perm_b32 v51, v115, v111, s71
buffer_load_dwordx4 v[100:103], v2, s[12:15], s30 offen offset:0 nt
buffer_load_dwordx4 v[104:107], v2, s[12:15], s30 offen offset:1024 nt
buffer_load_dwordx4 v[108:111], v2, s[12:15], s30 offen offset:2048 nt
buffer_load_dwordx4 v[112:115], v2, s[12:15], s30 offen offset:3072 nt
v_mfma_f32_16x16x16_bf16 v[52:55], v[36:37], v[16:17], v[52:55]
v_mfma_f32_16x16x16_bf16 v[56:59], v[38:39], v[16:17], v[56:59]
v_mfma_f32_16x16x16_bf16 v[60:63], v[40:41], v[16:17], v[60:63]
v_mfma_f32_16x16x16_bf16 v[64:67], v[42:43], v[16:17], v[64:67]
v_mfma_f32_16x16x16_bf16 v[68:71], v[44:45], v[16:17], v[68:71]
v_mfma_f32_16x16x16_bf16 v[72:75], v[46:47], v[16:17], v[72:75]
v_mfma_f32_16x16x16_bf16 v[76:79], v[48:49], v[16:17], v[76:79]
v_mfma_f32_16x16x16_bf16 v[80:83], v[50:51], v[16:17], v[80:83]
s_cmp_eq_u32 s29, s55
s_cbranch_scc1 L_rc1
s_waitcnt lgkmcnt(0)
s_cmp_lt_u32 s86, 112
s_cbranch_scc1 L_rc1
s_mov_b32 s61, 0
s_add_u32 s31, s31, 1
s_and_b32 s29, s31, 3
s_cmp_eq_u32 s61, 0
s_cselect_b32 s29, s55, s29
s_lshl_b32 s66, s29, 13
s_mov_b32 s86, 1
s_atomic_add s86, s[62:63], s66 glc
L_rc1:
s_branch L_loop1
L_loop0:
s_waitcnt vmcnt(4)
s_waitcnt lgkmcnt(0)
s_add_u32 s66, s86, 912
s_cmp_lt_u32 s66, 998
s_cbranch_scc1 L_tk1
ds_write_b32 v18, v18
s_waitcnt lgkmcnt(0)
s_cmp_ge_u32 s66, 1024
s_cbranch_scc1 L_drain0
L_tk1:
s_cmp_ge_u32 s66, 988
s_cselect_b32 s61, 0, s61
s_and_b32 s67, s66, 1
s_lshr_b32 s66, s66, 1
s_lshl_b32 s67, s67, 9
s_add_u32 s66, s66, s67
s_lshl_b32 s66, s66, 12
s_lshl_b32 s67, s29, 22
s_add_u32 s66, s66, s67
s_add_u32 s30, s28, s66
buffer_load_dwordx4 a[16:19], v1, s[8:11], s30 offen offset:0 nt
buffer_load_dwordx4 a[20:23], v1, s[8:11], s30 offen offset:1024 nt
buffer_load_dwordx4 a[24:27], v1, s[8:11], s30 offen offset:2048 nt
buffer_load_dwordx4 a[28:31], v1, s[8:11], s30 offen offset:3072 nt
s_add_u32 s31, s31, 1
s_and_b32 s29, s31, 3
s_cmp_eq_u32 s61, 0
s_cselect_b32 s29, s55, s29
s_lshl_b32 s66, s29, 13
s_mov_b32 s86, 1
s_atomic_add s86, s[62:63], s66 glc
v_mfma_f32_16x16x32_bf16 v[20:23], a[0:3], v[4:7], 0
v_mfma_f32_16x16x32_bf16 v[24:27], a[4:7], v[4:7], 0
v_mfma_f32_16x16x32_bf16 v[28:31], a[8:11], v[4:7], 0
v_mfma_f32_16x16x32_bf16 v[32:35], a[12:15], v[4:7], 0
s_nop 4
v_add_f32_dpp v12, v21, v20 row_ror:12 row_mask:0xf bank_mask:0x1
v_add_f32_dpp v13, v24, v25 row_ror:4 row_mask:0xf bank_mask:0x2
v_add_f32_dpp v14, v28, v30 row_ror:8 row_mask:0xf bank_mask:0x4
v_add_f32_dpp v15, v32, v35 row_ror:12 row_mask:0xf bank_mask:0x8
v_add_f32_dpp v12, v22, v12 row_ror:8 row_mask:0xf bank_mask:0x1
v_add_f32_dpp v13, v26, v13 row_ror:12 row_mask:0xf bank_mask:0x2
v_add_f32_dpp v14, v29, v14 row_ror:4 row_mask:0xf bank_mask:0x4
v_add_f32_dpp v15, v33, v15 row_ror:8 row_mask:0xf bank_mask:0x8
v_add_f32_dpp v11, v23, v12 row_ror:4 row_mask:0xf bank_mask:0x1
s_nop 1
v_add_f32_dpp v11, v27, v13 row_ror:8 row_mask:0xf bank_mask:0x2
s_nop 1
v_add_f32_dpp v11, v31, v14 row_ror:12 row_mask:0xf bank_mask:0x4
s_nop 1
v_add_f32_dpp v11, v34, v15 row_ror:4 row_mask:0xf bank_mask:0x8
v_cvt_pk_bf16_f32 v12, v11, v11
v_lshlrev_b32 v12, 16, v12
v_mul_f32 v12, s72, v12
v_cvt_pk_bf16_f32 v12, v12, v12
v_lshlrev_b32 v12, 16, v12
v_cmp_gt_f32 vcc, v12, v8
s_cbranch_vccz L_nr1
s_call_b64 s[64:65], L_rescale
L_nr1:
v_fma_f32 v12, v12, s73, -v9
v_exp_f32 v12, v12
s_nop 0
v_add_f32 v10, v10, v12
v_mov_b32_dpp v13, v12 row_ror:12 row_mask:0xf bank_mask:0xf
v_cvt_pk_bf16_f32 v16, v12, v13
s_nop 1
v_mov_b32_dpp v17, v16 row_ror:8 row_mask:0xf bank_mask:0xf
s_waitcnt vmcnt(4)
buffer_load_dwordx4 v[100:103], v2, s[12:15], s30 offen offset:0 nt
buffer_load_dwordx4 v[104:107], v2, s[12:15], s30 offen offset:1024 nt
buffer_load_dwordx4 v[108:111], v2, s[12:15], s30 offen offset:2048 nt
buffer_load_dwordx4 v[112:115], v2, s[12:15], s30 offen offset:3072 nt
s_cmp_eq_u32 s29, s55
s_cbranch_scc1 L_nck0
s_waitcnt lgkmcnt(0)
s_cmp_lt_u32 s86, 112
s_cbranch_scc1 L_nck0
s_mov_b32 s61, 0
s_add_u32 s31, s31, 1
s_and_b32 s29, s31, 3
s_cmp_eq_u32 s61, 0
s_cselect_b32 s29, s55, s29
s_lshl_b32 s66, s29, 13
s_mov_b32 s86, 1
s_atomic_add s86, s[62:63], s66 glc
L_nck0:
v_perm_b32 v36, v88, v84, s70
v_perm_b32 v38, v88, v84, s71
v_perm_b32 v40, v89, v85, s70
v_perm_b32 v42, v89, v85, s71
v_perm_b32 v44, v90, v86, s70
v_perm_b32 v46, v90, v86, s71
v_perm_b32 v48, v91, v87, s70
v_perm_b32 v50, v91, v87, s71
v_perm_b32 v37, v96, v92, s70
v_perm_b32 v39, v96, v92, s71
v_perm_b32 v41, v97, v93, s70
v_mfma_f32_16x16x16_bf16 v[52:55], v[36:37], v[16:17], v[52:55]
v_perm_b32 v43, v97, v93, s71
v_mfma_f32_16x16x16_bf16 v[56:59], v[38:39], v[16:17], v[56:59]
v_perm_b32 v45, v98, v94, s70
v_mfma_f32_16x16x16_bf16 v[60:63], v[40:41], v[16:17], v[60:63]
v_perm_b32 v47, v98, v94, s71
v_mfma_f32_16x16x16_bf16 v[64:67], v[42:43], v[16:17], v[64:67]
v_perm_b32 v49, v99, v95, s70
v_mfma_f32_16x16x16_bf16 v[68:71], v[44:45], v[16:17], v[68:71]
v_perm_b32 v51, v99, v95, s71
v_mfma_f32_16x16x16_bf16 v[72:75], v[46:47], v[16:17], v[72:75]
v_mfma_f32_16x16x16_bf16 v[76:79], v[48:49], v[16:17], v[76:79]
v_mfma_f32_16x16x16_bf16 v[80:83], v[50:51], v[16:17], v[80:83]
L_loop1:
s_waitcnt vmcnt(4)
s_waitcnt lgkmcnt(0)
s_add_u32 s66, s86, 912
s_cmp_lt_u32 s66, 998
s_cbranch_scc1 L_tk2
ds_write_b32 v18, v18
s_waitcnt lgkmcnt(0)
s_cmp_ge_u32 s66, 1024
s_cbranch_scc1 L_drain1
L_tk2:
s_cmp_ge_u32 s66, 988
s_cselect_b32 s61, 0, s61
s_and_b32 s67, s66, 1
s_lshr_b32 s66, s66, 1
s_lshl_b32 s67, s67, 9
s_add_u32 s66, s66, s67
s_lshl_b32 s66, s66, 12
s_lshl_b32 s67, s29, 22
s_add_u32 s66, s66, s67
s_add_u32 s30, s28, s66
buffer_load_dwordx4 a[0:3], v1, s[8:11], s30 offen offset:0 nt
buffer_load_dwordx4 a[4:7], v1, s[8:11], s30 offen offset:1024 nt
buffer_load_dwordx4 a[8:11], v1, s[8:11], s30 offen offset:2048 nt
buffer_load_dwordx4 a[12:15], v1, s[8:11], s30 offen offset:3072 nt
s_add_u32 s31, s31, 1
s_and_b32 s29, s31, 3
s_cmp_eq_u32 s61, 0
s_cselect_b32 s29, s55, s29
s_lshl_b32 s66, s29, 13
s_mov_b32 s86, 1
s_atomic_add s86, s[62:63], s66 glc
v_mfma_f32_16x16x32_bf16 v[20:23], a[16:19], v[4:7], 0
v_mfma_f32_16x16x32_bf16 v[24:27], a[20:23], v[4:7], 0
v_mfma_f32_16x16x32_bf16 v[28:31], a[24:27], v[4:7], 0
v_mfma_f32_16x16x32_bf16 v[32:35], a[28:31], v[4:7], 0
s_nop 4
v_add_f32_dpp v12, v21, v20 row_ror:12 row_mask:0xf bank_mask:0x1
v_add_f32_dpp v13, v24, v25 row_ror:4 row_mask:0xf bank_mask:0x2
v_add_f32_dpp v14, v28, v30 row_ror:8 row_mask:0xf bank_mask:0x4
v_add_f32_dpp v15, v32, v35 row_ror:12 row_mask:0xf bank_mask:0x8
v_add_f32_dpp v12, v22, v12 row_ror:8 row_mask:0xf bank_mask:0x1
v_add_f32_dpp v13, v26, v13 row_ror:12 row_mask:0xf bank_mask:0x2
v_add_f32_dpp v14, v29, v14 row_ror:4 row_mask:0xf bank_mask:0x4
v_add_f32_dpp v15, v33, v15 row_ror:8 row_mask:0xf bank_mask:0x8
v_add_f32_dpp v11, v23, v12 row_ror:4 row_mask:0xf bank_mask:0x1
s_nop 1
v_add_f32_dpp v11, v27, v13 row_ror:8 row_mask:0xf bank_mask:0x2
s_nop 1
v_add_f32_dpp v11, v31, v14 row_ror:12 row_mask:0xf bank_mask:0x4
s_nop 1
v_add_f32_dpp v11, v34, v15 row_ror:4 row_mask:0xf bank_mask:0x8
v_cvt_pk_bf16_f32 v12, v11, v11
v_lshlrev_b32 v12, 16, v12
v_mul_f32 v12, s72, v12
v_cvt_pk_bf16_f32 v12, v12, v12
v_lshlrev_b32 v12, 16, v12
v_cmp_gt_f32 vcc, v12, v8
s_cbranch_vccz L_nr2
s_call_b64 s[64:65], L_rescale
L_nr2:
v_fma_f32 v12, v12, s73, -v9
v_exp_f32 v12, v12
s_nop 0
v_add_f32 v10, v10, v12
v_mov_b32_dpp v13, v12 row_ror:12 row_mask:0xf bank_mask:0xf
v_cvt_pk_bf16_f32 v16, v12, v13
s_nop 1
v_mov_b32_dpp v17, v16 row_ror:8 row_mask:0xf bank_mask:0xf
s_waitcnt vmcnt(4)
buffer_load_dwordx4 v[84:87], v2, s[12:15], s30 offen offset:0 nt
buffer_load_dwordx4 v[88:91], v2, s[12:15], s30 offen offset:1024 nt
buffer_load_dwordx4 v[92:95], v2, s[12:15], s30 offen offset:2048 nt
buffer_load_dwordx4 v[96:99], v2, s[12:15], s30 offen offset:3072 nt
s_cmp_eq_u32 s29, s55
s_cbranch_scc1 L_nck1
s_waitcnt lgkmcnt(0)
s_cmp_lt_u32 s86, 112
s_cbranch_scc1 L_nck1
s_mov_b32 s61, 0
s_add_u32 s31, s31, 1
s_and_b32 s29, s31, 3
s_cmp_eq_u32 s61, 0
s_cselect_b32 s29, s55, s29
s_lshl_b32 s66, s29, 13
s_mov_b32 s86, 1
s_atomic_add s86, s[62:63], s66 glc
L_nck1:
v_perm_b32 v36, v104, v100, s70
v_perm_b32 v38, v104, v100, s71
v_perm_b32 v40, v105, v101, s70
v_perm_b32 v42, v105, v101, s71
v_perm_b32 v44, v106, v102, s70
v_perm_b32 v46, v106, v102, s71
v_perm_b32 v48, v107, v103, s70
v_perm_b32 v50, v107, v103, s71
v_perm_b32 v37, v112, v108, s70
v_perm_b32 v39, v112, v108, s71
v_perm_b32 v41, v113, v109, s70
v_mfma_f32_16x16x16_bf16 v[52:55], v[36:37], v[16:17], v[52:55]
v_perm_b32 v43, v113, v109, s71
v_mfma_f32_16x16x16_bf16 v[56:59], v[38:39], v[16:17], v[56:59]
v_perm_b32 v45, v114, v110, s70
v_mfma_f32_16x16x16_bf16 v[60:63], v[40:41], v[16:17], v[60:63]
v_perm_b32 v47, v114, v110, s71
v_mfma_f32_16x16x16_bf16 v[64:67], v[42:43], v[16:17], v[64:67]
v_perm_b32 v49, v115, v111, s70
v_mfma_f32_16x16x16_bf16 v[68:71], v[44:45], v[16:17], v[68:71]
v_perm_b32 v51, v115, v111, s71
v_mfma_f32_16x16x16_bf16 v[72:75], v[46:47], v[16:17], v[72:75]
v_mfma_f32_16x16x16_bf16 v[76:79], v[48:49], v[16:17], v[76:79]
v_mfma_f32_16x16x16_bf16 v[80:83], v[50:51], v[16:17], v[80:83]
s_branch L_loop0
L_nodyn:
v_mfma_f32_16x16x16_bf16 v[52:55], v[36:37], v[16:17], v[52:55]
v_mfma_f32_16x16x16_bf16 v[56:59], v[38:39], v[16:17], v[56:59]
v_mfma_f32_16x16x16_bf16 v[60:63], v[40:41], v[16:17], v[60:63]
v_mfma_f32_16x16x16_bf16 v[64:67], v[42:43], v[16:17], v[64:67]
v_mfma_f32_16x16x16_bf16 v[68:71], v[44:45], v[16:17], v[68:71]
v_mfma_f32_16x16x16_bf16 v[72:75], v[46:47], v[16:17], v[72:75]
v_mfma_f32_16x16x16_bf16 v[76:79], v[48:49], v[16:17], v[76:79]
v_mfma_f32_16x16x16_bf16 v[80:83], v[50:51], v[16:17], v[80:83]
s_lshl_b32 s66, s54, 2
s_lshr_b32 s67, s77, 3
s_add_u32 s66, s66, s67
s_lshl_b32 s68, s66, 3
s_and_b32 s67, s77, 4
s_add_u32 s67, s67, s3
s_add_u32 s68, s68, s67
s_lshl_b32 s66, s66, 7
s_add_u32 s66, s66, s67
s_lshl_b32 s66, s66, 10
s_and_b32 s67, s77, 3
s_lshl_b32 s69, s67, 8
s_add_u32 s89, s66, s69
v_lshrrev_b32 v152, 5, v0
v_and_b32 v153, 31, v0
v_lshlrev_b32 v154, 13, v152
v_lshl_add_u32 v154, v153, 3, v154
s_lshr_b32 s78, s68, 1
s_lshl_b32 s78, s78, 12
s_and_b32 s66, s68, 1
s_lshl_b32 s66, s66, 6
s_add_u32 s78, s78, s66
s_add_u32 s78, s78, 786432
s_lshl_b32 s80, s67, 16
s_lshl_b32 s66, s54, 3
s_add_u32 s66, s66, s52
s_lshl_b32 s66, s66, 7
s_add_u32 s80, s80, s66
s_add_u32 s80, s80, 1310720
s_lshl_b32 s88, s53, 5
s_lshl_b32 s66, s53, 13
s_add_u32 s81, s66, 1310720
s_add_u32 s87, s66, 458752
s_lshl_b32 s76, s54, 16
s_lshl_b32 s66, s3, 14
s_add_u32 s76, s76, s66
s_lshl_b32 s66, s56, 7
s_add_u32 s76, s76, s66
s_add_u32 s76, s76, 786432
s_mov_b32 s82, 0xaaaaaaaa
s_mov_b32 s83, 0xaaaaaaaa
v_mov_b32 v148, 0
ds_read_b64 v[138:139], v148 offset:2048
s_lshl_b32 s66, s3, 9
v_lshl_add_u32 v144, v153, 1, v152
v_lshl_add_u32 v144, v144, 3, s66
v_lshlrev_b32 v155, 4, v153
v_lshl_add_u32 v155, v152, 10, v155
s_mul_i32 s66, s3, 528
v_lshl_add_u32 v140, v153, 4, s66
v_and_b32 v153, 7, v0
v_lshl_add_u32 v146, v153, 1, v152
v_lshlrev_b32 v146, 1, v146
v_lshrrev_b32 v152, 3, v0
v_lshlrev_b32 v153, 4, v153
v_lshl_add_u32 v145, v152, 13, v153
v_lshl_add_u32 v142, v152, 12, v153
v_and_b32 v153, 3, v0
v_lshrrev_b32 v152, 2, v0
v_lshlrev_b32 v156, 7, v152
v_lshl_add_u32 v156, v153, 4, v156
s_sub_u32 s66, s3, 1
s_mul_i32 s67, s66, 2112
s_lshl_b32 s66, s66, 5
s_add_u32 s66, s66, 2080
v_lshl_add_u32 v150, v153, 3, s66
v_mul_u32_u24 v149, 528, v153
v_lshrrev_b32 v152, 4, v0
v_lshl_add_u32 v149, v152, 4, v149
v_add_u32 v149, s67, v149
v_lshlrev_b32 v151, 3, v0
s_lshl_b32 s66, s3, 3
v_mov_b32 v141, s66
v_lshlrev_b32 v143, 4, v0
v_fma_f32 v12, v120, s73, -v9
v_exp_f32 v12, v12
s_nop 0
v_add_f32 v10, v10, v12
v_mov_b32_dpp v13, v12 row_ror:12 row_mask:0xf bank_mask:0xf
v_cvt_pk_bf16_f32 v16, v12, v13
s_nop 1
v_mov_b32_dpp v17, v16 row_ror:8 row_mask:0xf bank_mask:0xf
v_add_f32_dpp v19, v10, v10 row_ror:4 row_mask:0xf bank_mask:0xf
s_nop 1
v_add_f32_dpp v19, v19, v19 row_ror:8 row_mask:0xf bank_mask:0xf
v_mov_b32 v14, v19
s_nop 1
v_permlane16_swap_b32 v14, v19
v_add_f32 v19, v19, v14
v_mov_b32 v14, v19
s_nop 1
v_permlane32_swap_b32 v14, v19
v_add_f32 v19, v19, v14
s_mov_b32 exec_lo, 0x000f000f
s_mov_b32 exec_hi, 0x000f000f
ds_write2_b32 v150, v9, v19 offset0:0 offset1:1
s_mov_b64 exec, -1
s_waitcnt vmcnt(2)
v_perm_b32 v36, v104, v100, s70
v_perm_b32 v38, v104, v100, s71
v_perm_b32 v40, v105, v101, s70
v_perm_b32 v42, v105, v101, s71
v_perm_b32 v44, v106, v102, s70
v_perm_b32 v46, v106, v102, s71
v_perm_b32 v48, v107, v103, s70
v_perm_b32 v50, v107, v103, s71
s_waitcnt vmcnt(0)
v_perm_b32 v37, v112, v108, s70
v_perm_b32 v39, v112, v108, s71
v_perm_b32 v41, v113, v109, s70
v_mfma_f32_16x16x16_bf16 v[52:55], v[36:37], v[16:17], v[52:55]
v_perm_b32 v43, v113, v109, s71
v_mfma_f32_16x16x16_bf16 v[56:59], v[38:39], v[16:17], v[56:59]
v_perm_b32 v45, v114, v110, s70
v_mfma_f32_16x16x16_bf16 v[60:63], v[40:41], v[16:17], v[60:63]
v_perm_b32 v47, v114, v110, s71
v_mfma_f32_16x16x16_bf16 v[64:67], v[42:43], v[16:17], v[64:67]
v_perm_b32 v49, v115, v111, s70
v_mfma_f32_16x16x16_bf16 v[68:71], v[44:45], v[16:17], v[68:71]
v_perm_b32 v51, v115, v111, s71
v_mfma_f32_16x16x16_bf16 v[72:75], v[46:47], v[16:17], v[72:75]
v_mfma_f32_16x16x16_bf16 v[76:79], v[48:49], v[16:17], v[76:79]
v_mfma_f32_16x16x16_bf16 v[80:83], v[50:51], v[16:17], v[80:83]
s_branch L_fin
L_drain0:
s_lshl_b32 s66, s54, 2
s_lshr_b32 s67, s77, 3
s_add_u32 s66, s66, s67
s_lshl_b32 s68, s66, 3
s_and_b32 s67, s77, 4
s_add_u32 s67, s67, s3
s_add_u32 s68, s68, s67
s_lshl_b32 s66, s66, 7
s_add_u32 s66, s66, s67
s_lshl_b32 s66, s66, 10
s_and_b32 s67, s77, 3
s_lshl_b32 s69, s67, 8
s_add_u32 s89, s66, s69
v_lshrrev_b32 v152, 5, v0
v_and_b32 v153, 31, v0
v_lshlrev_b32 v154, 13, v152
v_lshl_add_u32 v154, v153, 3, v154
s_lshr_b32 s78, s68, 1
s_lshl_b32 s78, s78, 12
s_and_b32 s66, s68, 1
s_lshl_b32 s66, s66, 6
s_add_u32 s78, s78, s66
s_add_u32 s78, s78, 786432
s_lshl_b32 s80, s67, 16
s_lshl_b32 s66, s54, 3
s_add_u32 s66, s66, s52
s_lshl_b32 s66, s66, 7
s_add_u32 s80, s80, s66
s_add_u32 s80, s80, 1310720
s_lshl_b32 s88, s53, 5
s_lshl_b32 s66, s53, 13
s_add_u32 s81, s66, 1310720
s_add_u32 s87, s66, 458752
s_lshl_b32 s76, s54, 16
s_lshl_b32 s66, s3, 14
s_add_u32 s76, s76, s66
s_lshl_b32 s66, s56, 7
s_add_u32 s76, s76, s66
s_add_u32 s76, s76, 786432
s_mov_b32 s82, 0xaaaaaaaa
s_mov_b32 s83, 0xaaaaaaaa
v_mov_b32 v148, 0
ds_read_b64 v[138:139], v148 offset:2048
s_lshl_b32 s66, s3, 9
v_lshl_add_u32 v144, v153, 1, v152
v_lshl_add_u32 v144, v144, 3, s66
v_lshlrev_b32 v155, 4, v153
v_lshl_add_u32 v155, v152, 10, v155
s_mul_i32 s66, s3, 528
v_lshl_add_u32 v140, v153, 4, s66
v_and_b32 v153, 7, v0
v_lshl_add_u32 v146, v153, 1, v152
v_lshlrev_b32 v146, 1, v146
v_lshrrev_b32 v152, 3, v0
v_lshlrev_b32 v153, 4, v153
v_lshl_add_u32 v145, v152, 13, v153
v_lshl_add_u32 v142, v152, 12, v153
v_and_b32 v153, 3, v0
v_lshrrev_b32 v152, 2, v0
v_lshlrev_b32 v156, 7, v152
v_lshl_add_u32 v156, v153, 4, v156
s_sub_u32 s66, s3, 1
s_mul_i32 s67, s66, 2112
s_lshl_b32 s66, s66, 5
s_add_u32 s66, s66, 2080
v_lshl_add_u32 v150, v153, 3, s66
v_mul_u32_u24 v149, 528, v153
v_lshrrev_b32 v152, 4, v0
v_lshl_add_u32 v149, v152, 4, v149
v_add_u32 v149, s67, v149
v_lshlrev_b32 v151, 3, v0
s_lshl_b32 s66, s3, 3
v_mov_b32 v141, s66
v_lshlrev_b32 v143, 4, v0
v_mfma_f32_16x16x32_bf16 v[20:23], a[0:3], v[4:7], 0
v_mfma_f32_16x16x32_bf16 v[24:27], a[4:7], v[4:7], 0
v_mfma_f32_16x16x32_bf16 v[28:31], a[8:11], v[4:7], 0
v_mfma_f32_16x16x32_bf16 v[32:35], a[12:15], v[4:7], 0
s_nop 4
v_add_f32_dpp v12, v21, v20 row_ror:12 row_mask:0xf bank_mask:0x1
v_add_f32_dpp v13, v24, v25 row_ror:4 row_mask:0xf bank_mask:0x2
v_add_f32_dpp v14, v28, v30 row_ror:8 row_mask:0xf bank_mask:0x4
v_add_f32_dpp v15, v32, v35 row_ror:12 row_mask:0xf bank_mask:0x8
v_add_f32_dpp v12, v22, v12 row_ror:8 row_mask:0xf bank_mask:0x1
v_add_f32_dpp v13, v26, v13 row_ror:12 row_mask:0xf bank_mask:0x2
v_add_f32_dpp v14, v29, v14 row_ror:4 row_mask:0xf bank_mask:0x4
v_add_f32_dpp v15, v33, v15 row_ror:8 row_mask:0xf bank_mask:0x8
v_add_f32_dpp v11, v23, v12 row_ror:4 row_mask:0xf bank_mask:0x1
s_nop 1
v_add_f32_dpp v11, v27, v13 row_ror:8 row_mask:0xf bank_mask:0x2
s_nop 1
v_add_f32_dpp v11, v31, v14 row_ror:12 row_mask:0xf bank_mask:0x4
s_nop 1
v_add_f32_dpp v11, v34, v15 row_ror:4 row_mask:0xf bank_mask:0x8
v_cvt_pk_bf16_f32 v12, v11, v11
v_lshlrev_b32 v12, 16, v12
v_mul_f32 v12, s72, v12
v_cvt_pk_bf16_f32 v12, v12, v12
v_lshlrev_b32 v12, 16, v12
v_cmp_gt_f32 vcc, v12, v8
s_cbranch_vccz L_nr3
s_call_b64 s[64:65], L_rescale
L_nr3:
v_fma_f32 v12, v12, s73, -v9
v_exp_f32 v12, v12
s_nop 0
v_add_f32 v10, v10, v12
v_mov_b32_dpp v13, v12 row_ror:12 row_mask:0xf bank_mask:0xf
v_cvt_pk_bf16_f32 v16, v12, v13
s_nop 1
v_mov_b32_dpp v17, v16 row_ror:8 row_mask:0xf bank_mask:0xf
v_add_f32_dpp v19, v10, v10 row_ror:4 row_mask:0xf bank_mask:0xf
s_nop 1
v_add_f32_dpp v19, v19, v19 row_ror:8 row_mask:0xf bank_mask:0xf
v_mov_b32 v14, v19
s_nop 1
v_permlane16_swap_b32 v14, v19
v_add_f32 v19, v19, v14
v_mov_b32 v14, v19
s_nop 1
v_permlane32_swap_b32 v14, v19
v_add_f32 v19, v19, v14
s_mov_b32 exec_lo, 0x000f000f
s_mov_b32 exec_hi, 0x000f000f
ds_write2_b32 v150, v9, v19 offset0:0 offset1:1
s_mov_b64 exec, -1
s_waitcnt vmcnt(2)
v_perm_b32 v36, v88, v84, s70
v_perm_b32 v38, v88, v84, s71
v_perm_b32 v40, v89, v85, s70
v_perm_b32 v42, v89, v85, s71
v_perm_b32 v44, v90, v86, s70
v_perm_b32 v46, v90, v86, s71
v_perm_b32 v48, v91, v87, s70
v_perm_b32 v50, v91, v87, s71
s_waitcnt vmcnt(0)
v_perm_b32 v37, v96, v92, s70
v_perm_b32 v39, v96, v92, s71
v_perm_b32 v41, v97, v93, s70
v_mfma_f32_16x16x16_bf16 v[52:55], v[36:37], v[16:17], v[52:55]
v_perm_b32 v43, v97, v93, s71
v_mfma_f32_16x16x16_bf16 v[56:59], v[38:39], v[16:17], v[56:59]
v_perm_b32 v45, v98, v94, s70
v_mfma_f32_16x16x16_bf16 v[60:63], v[40:41], v[16:17], v[60:63]
v_perm_b32 v47, v98, v94, s71
v_mfma_f32_16x16x16_bf16 v[64:67], v[42:43], v[16:17], v[64:67]
v_perm_b32 v49, v99, v95, s70
v_mfma_f32_16x16x16_bf16 v[68:71], v[44:45], v[16:17], v[68:71]
v_perm_b32 v51, v99, v95, s71
v_mfma_f32_16x16x16_bf16 v[72:75], v[46:47], v[16:17], v[72:75]
v_mfma_f32_16x16x16_bf16 v[76:79], v[48:49], v[16:17], v[76:79]
v_mfma_f32_16x16x16_bf16 v[80:83], v[50:51], v[16:17], v[80:83]
s_branch L_fin
L_drain1:
s_lshl_b32 s66, s54, 2
s_lshr_b32 s67, s77, 3
s_add_u32 s66, s66, s67
s_lshl_b32 s68, s66, 3
s_and_b32 s67, s77, 4
s_add_u32 s67, s67, s3
s_add_u32 s68, s68, s67
s_lshl_b32 s66, s66, 7
s_add_u32 s66, s66, s67
s_lshl_b32 s66, s66, 10
s_and_b32 s67, s77, 3
s_lshl_b32 s69, s67, 8
s_add_u32 s89, s66, s69
v_lshrrev_b32 v152, 5, v0
v_and_b32 v153, 31, v0
v_lshlrev_b32 v154, 13, v152
v_lshl_add_u32 v154, v153, 3, v154
s_lshr_b32 s78, s68, 1
s_lshl_b32 s78, s78, 12
s_and_b32 s66, s68, 1
s_lshl_b32 s66, s66, 6
s_add_u32 s78, s78, s66
s_add_u32 s78, s78, 786432
s_lshl_b32 s80, s67, 16
s_lshl_b32 s66, s54, 3
s_add_u32 s66, s66, s52
s_lshl_b32 s66, s66, 7
s_add_u32 s80, s80, s66
s_add_u32 s80, s80, 1310720
s_lshl_b32 s88, s53, 5
s_lshl_b32 s66, s53, 13
s_add_u32 s81, s66, 1310720
s_add_u32 s87, s66, 458752
s_lshl_b32 s76, s54, 16
s_lshl_b32 s66, s3, 14
s_add_u32 s76, s76, s66
s_lshl_b32 s66, s56, 7
s_add_u32 s76, s76, s66
s_add_u32 s76, s76, 786432
s_mov_b32 s82, 0xaaaaaaaa
s_mov_b32 s83, 0xaaaaaaaa
v_mov_b32 v148, 0
ds_read_b64 v[138:139], v148 offset:2048
s_lshl_b32 s66, s3, 9
v_lshl_add_u32 v144, v153, 1, v152
v_lshl_add_u32 v144, v144, 3, s66
v_lshlrev_b32 v155, 4, v153
v_lshl_add_u32 v155, v152, 10, v155
s_mul_i32 s66, s3, 528
v_lshl_add_u32 v140, v153, 4, s66
v_and_b32 v153, 7, v0
v_lshl_add_u32 v146, v153, 1, v152
v_lshlrev_b32 v146, 1, v146
v_lshrrev_b32 v152, 3, v0
v_lshlrev_b32 v153, 4, v153
v_lshl_add_u32 v145, v152, 13, v153
v_lshl_add_u32 v142, v152, 12, v153
v_and_b32 v153, 3, v0
v_lshrrev_b32 v152, 2, v0
v_lshlrev_b32 v156, 7, v152
v_lshl_add_u32 v156, v153, 4, v156
s_sub_u32 s66, s3, 1
s_mul_i32 s67, s66, 2112
s_lshl_b32 s66, s66, 5
s_add_u32 s66, s66, 2080
v_lshl_add_u32 v150, v153, 3, s66
v_mul_u32_u24 v149, 528, v153
v_lshrrev_b32 v152, 4, v0
v_lshl_add_u32 v149, v152, 4, v149
v_add_u32 v149, s67, v149
v_lshlrev_b32 v151, 3, v0
s_lshl_b32 s66, s3, 3
v_mov_b32 v141, s66
v_lshlrev_b32 v143, 4, v0
v_mfma_f32_16x16x32_bf16 v[20:23], a[16:19], v[4:7], 0
v_mfma_f32_16x16x32_bf16 v[24:27], a[20:23], v[4:7], 0
v_mfma_f32_16x16x32_bf16 v[28:31], a[24:27], v[4:7], 0
v_mfma_f32_16x16x32_bf16 v[32:35], a[28:31], v[4:7], 0
s_nop 4
v_add_f32_dpp v12, v21, v20 row_ror:12 row_mask:0xf bank_mask:0x1
v_add_f32_dpp v13, v24, v25 row_ror:4 row_mask:0xf bank_mask:0x2
v_add_f32_dpp v14, v28, v30 row_ror:8 row_mask:0xf bank_mask:0x4
v_add_f32_dpp v15, v32, v35 row_ror:12 row_mask:0xf bank_mask:0x8
v_add_f32_dpp v12, v22, v12 row_ror:8 row_mask:0xf bank_mask:0x1
v_add_f32_dpp v13, v26, v13 row_ror:12 row_mask:0xf bank_mask:0x2
v_add_f32_dpp v14, v29, v14 row_ror:4 row_mask:0xf bank_mask:0x4
v_add_f32_dpp v15, v33, v15 row_ror:8 row_mask:0xf bank_mask:0x8
v_add_f32_dpp v11, v23, v12 row_ror:4 row_mask:0xf bank_mask:0x1
s_nop 1
v_add_f32_dpp v11, v27, v13 row_ror:8 row_mask:0xf bank_mask:0x2
s_nop 1
v_add_f32_dpp v11, v31, v14 row_ror:12 row_mask:0xf bank_mask:0x4
s_nop 1
v_add_f32_dpp v11, v34, v15 row_ror:4 row_mask:0xf bank_mask:0x8
v_cvt_pk_bf16_f32 v12, v11, v11
v_lshlrev_b32 v12, 16, v12
v_mul_f32 v12, s72, v12
v_cvt_pk_bf16_f32 v12, v12, v12
v_lshlrev_b32 v12, 16, v12
v_cmp_gt_f32 vcc, v12, v8
s_cbranch_vccz L_nr4
s_call_b64 s[64:65], L_rescale
L_nr4:
v_fma_f32 v12, v12, s73, -v9
v_exp_f32 v12, v12
s_nop 0
v_add_f32 v10, v10, v12
v_mov_b32_dpp v13, v12 row_ror:12 row_mask:0xf bank_mask:0xf
v_cvt_pk_bf16_f32 v16, v12, v13
s_nop 1
v_mov_b32_dpp v17, v16 row_ror:8 row_mask:0xf bank_mask:0xf
v_add_f32_dpp v19, v10, v10 row_ror:4 row_mask:0xf bank_mask:0xf
s_nop 1
v_add_f32_dpp v19, v19, v19 row_ror:8 row_mask:0xf bank_mask:0xf
v_mov_b32 v14, v19
s_nop 1
v_permlane16_swap_b32 v14, v19
v_add_f32 v19, v19, v14
v_mov_b32 v14, v19
s_nop 1
v_permlane32_swap_b32 v14, v19
v_add_f32 v19, v19, v14
s_mov_b32 exec_lo, 0x000f000f
s_mov_b32 exec_hi, 0x000f000f
ds_write2_b32 v150, v9, v19 offset0:0 offset1:1
s_mov_b64 exec, -1
s_waitcnt vmcnt(2)
v_perm_b32 v36, v104, v100, s70
v_perm_b32 v38, v104, v100, s71
v_perm_b32 v40, v105, v101, s70
v_perm_b32 v42, v105, v101, s71
v_perm_b32 v44, v106, v102, s70
v_perm_b32 v46, v106, v102, s71
v_perm_b32 v48, v107, v103, s70
v_perm_b32 v50, v107, v103, s71
s_waitcnt vmcnt(0)
v_perm_b32 v37, v112, v108, s70
v_perm_b32 v39, v112, v108, s71
v_perm_b32 v41, v113, v109, s70
v_mfma_f32_16x16x16_bf16 v[52:55], v[36:37], v[16:17], v[52:55]
v_perm_b32 v43, v113, v109, s71
v_mfma_f32_16x16x16_bf16 v[56:59], v[38:39], v[16:17], v[56:59]
v_perm_b32 v45, v114, v110, s70
v_mfma_f32_16x16x16_bf16 v[60:63], v[40:41], v[16:17], v[60:63]
v_perm_b32 v47, v114, v110, s71
v_mfma_f32_16x16x16_bf16 v[64:67], v[42:43], v[16:17], v[64:67]
v_perm_b32 v49, v115, v111, s70
v_mfma_f32_16x16x16_bf16 v[68:71], v[44:45], v[16:17], v[68:71]
v_perm_b32 v51, v115, v111, s71
v_mfma_f32_16x16x16_bf16 v[72:75], v[46:47], v[16:17], v[72:75]
v_mfma_f32_16x16x16_bf16 v[76:79], v[48:49], v[16:17], v[76:79]
v_mfma_f32_16x16x16_bf16 v[80:83], v[50:51], v[16:17], v[80:83]
L_fin:
s_mov_b32 exec_lo, 0x000f000f
s_mov_b32 exec_hi, 0x000f000f
ds_write_b128 v149, v[52:55] offset:2176
ds_write_b128 v149, v[56:59] offset:2240
ds_write_b128 v149, v[60:63] offset:2304
ds_write_b128 v149, v[64:67] offset:2368
ds_write_b128 v149, v[68:71] offset:2432
ds_write_b128 v149, v[72:75] offset:2496
ds_write_b128 v149, v[76:79] offset:2560
ds_write_b128 v149, v[80:83] offset:2624
s_mov_b64 exec, -1
buffer_load_dwordx2 v[116:117], v154, s[20:23], s89 offen nt
s_add_u32 s89, s89, 16384
buffer_load_dwordx2 v[118:119], v154, s[20:23], s89 offen nt
s_add_u32 s89, s89, 16384
buffer_load_dwordx2 v[120:121], v154, s[20:23], s89 offen nt
s_add_u32 s89, s89, 16384
buffer_load_dwordx2 v[122:123], v154, s[20:23], s89 offen nt
s_add_u32 s89, s89, 16384
buffer_load_dwordx2 v[124:125], v154, s[20:23], s89 offen nt
s_add_u32 s89, s89, 16384
buffer_load_dwordx2 v[126:127], v154, s[20:23], s89 offen nt
s_add_u32 s89, s89, 16384
buffer_load_dwordx2 v[128:129], v154, s[20:23], s89 offen nt
s_add_u32 s89, s89, 16384
buffer_load_dwordx2 v[130:131], v154, s[20:23], s89 offen nt
s_branch L_tail
L_rescale:
v_max_f32 v13, v12, v8
s_nop 1
v_max_f32_dpp v13, v13, v13 row_ror:4 row_mask:0xf bank_mask:0xf
s_nop 1
v_max_f32_dpp v13, v13, v13 row_ror:8 row_mask:0xf bank_mask:0xf
v_mov_b32 v14, v13
s_nop 1
v_permlane16_swap_b32 v14, v13
v_max_f32 v13, v13, v14
v_mov_b32 v14, v13
s_nop 1
v_permlane32_swap_b32 v14, v13
v_max_f32 v13, v13, v14
v_mov_b32 v8, v13
v_mul_f32 v13, s73, v13
v_sub_f32 v14, v9, v13
v_exp_f32 v14, v14
v_mov_b32 v9, v13
v_mul_f32 v10, v10, v14
v_pk_mul_f32 v[52:53], v[52:53], v[14:15] op_sel_hi:[1,0]
v_pk_mul_f32 v[54:55], v[54:55], v[14:15] op_sel_hi:[1,0]
v_pk_mul_f32 v[56:57], v[56:57], v[14:15] op_sel_hi:[1,0]
v_pk_mul_f32 v[58:59], v[58:59], v[14:15] op_sel_hi:[1,0]
v_pk_mul_f32 v[60:61], v[60:61], v[14:15] op_sel_hi:[1,0]
v_pk_mul_f32 v[62:63], v[62:63], v[14:15] op_sel_hi:[1,0]
v_pk_mul_f32 v[64:65], v[64:65], v[14:15] op_sel_hi:[1,0]
v_pk_mul_f32 v[66:67], v[66:67], v[14:15] op_sel_hi:[1,0]
v_pk_mul_f32 v[68:69], v[68:69], v[14:15] op_sel_hi:[1,0]
v_pk_mul_f32 v[70:71], v[70:71], v[14:15] op_sel_hi:[1,0]
v_pk_mul_f32 v[72:73], v[72:73], v[14:15] op_sel_hi:[1,0]
v_pk_mul_f32 v[74:75], v[74:75], v[14:15] op_sel_hi:[1,0]
v_pk_mul_f32 v[76:77], v[76:77], v[14:15] op_sel_hi:[1,0]
v_pk_mul_f32 v[78:79], v[78:79], v[14:15] op_sel_hi:[1,0]
v_pk_mul_f32 v[80:81], v[80:81], v[14:15] op_sel_hi:[1,0]
v_pk_mul_f32 v[82:83], v[82:83], v[14:15] op_sel_hi:[1,0]
s_setpc_b64 s[64:65]
L_svc2:
s_lshl_b32 s66, s54, 2
s_lshr_b32 s67, s77, 3
s_add_u32 s66, s66, s67
s_lshl_b32 s68, s66, 3
s_and_b32 s67, s77, 4
s_add_u32 s67, s67, s3
s_add_u32 s68, s68, s67
s_lshl_b32 s66, s66, 7
s_add_u32 s66, s66, s67
s_lshl_b32 s66, s66, 10
s_and_b32 s67, s77, 3
s_lshl_b32 s69, s67, 8
s_add_u32 s89, s66, s69
v_lshrrev_b32 v152, 5, v0
v_and_b32 v153, 31, v0
v_lshlrev_b32 v154, 13, v152
v_lshl_add_u32 v154, v153, 3, v154
s_lshr_b32 s78, s68, 1
s_lshl_b32 s78, s78, 12
s_and_b32 s66, s68, 1
s_lshl_b32 s66, s66, 6
s_add_u32 s78, s78, s66
s_add_u32 s78, s78, 786432
s_lshl_b32 s80, s67, 16
s_lshl_b32 s66, s54, 3
s_add_u32 s66, s66, s52
s_lshl_b32 s66, s66, 7
s_add_u32 s80, s80, s66
s_add_u32 s80, s80, 1310720
s_lshl_b32 s88, s53, 5
s_lshl_b32 s66, s53, 13
s_add_u32 s81, s66, 1310720
s_add_u32 s87, s66, 458752
s_lshl_b32 s76, s54, 16
s_lshl_b32 s66, s3, 14
s_add_u32 s76, s76, s66
s_lshl_b32 s66, s56, 7
s_add_u32 s76, s76, s66
s_add_u32 s76, s76, 786432
s_mov_b32 s82, 0xaaaaaaaa
s_mov_b32 s83, 0xaaaaaaaa
v_mov_b32 v148, 0
ds_read_b64 v[138:139], v148 offset:2048
s_lshl_b32 s66, s3, 9
v_lshl_add_u32 v144, v153, 1, v152
v_lshl_add_u32 v144, v144, 3, s66
v_lshlrev_b32 v155, 4, v153
v_lshl_add_u32 v155, v152, 10, v155
s_mul_i32 s66, s3, 528
v_lshl_add_u32 v140, v153, 4, s66
v_and_b32 v153, 7, v0
v_lshl_add_u32 v146, v153, 1, v152
v_lshlrev_b32 v146, 1, v146
v_lshrrev_b32 v152, 3, v0
v_lshlrev_b32 v153, 4, v153
v_lshl_add_u32 v145, v152, 13, v153
v_lshl_add_u32 v142, v152, 12, v153
v_and_b32 v153, 3, v0
v_lshrrev_b32 v152, 2, v0
v_lshlrev_b32 v156, 7, v152
v_lshl_add_u32 v156, v153, 4, v156
s_sub_u32 s66, s3, 1
s_mul_i32 s67, s66, 2112
s_lshl_b32 s66, s66, 5
s_add_u32 s66, s66, 2080
v_lshl_add_u32 v150, v153, 3, s66
v_mul_u32_u24 v149, 528, v153
v_lshrrev_b32 v152, 4, v0
v_lshl_add_u32 v149, v152, 4, v149
v_add_u32 v149, s67, v149
v_lshlrev_b32 v151, 3, v0
s_lshl_b32 s66, s3, 3
v_mov_b32 v141, s66
v_lshlrev_b32 v143, 4, v0
v_mul_u32_u24 v6, 28672, v4
v_lshl_add_u32 v6, v5, 4, v6
s_mul_i32 s28, s52, 229376
s_lshl_b32 s67, s53, 7
s_add_u32 s28, s28, s67
s_lshl_b32 s67, s52, 7
v_lshl_add_u32 v7, v4, 4, s67
ds_read_b128 v[24:27], v7 offset:0
v_lshlrev_b32 v23, 4, v22
v_lshlrev_b32 v7, 2, v0
s_lshl_b32 s29, s53, 13
s_add_u32 s29, s29, 196608
s_lshl_b32 s67, s52, 10
s_add_u32 s30, s29, s67
s_lshr_b32 s67, s52, 2
s_lshl_b32 s68, s67, 9
s_add_u32 s29, s29, s68
s_lshl_b32 s68, s53, 1
s_add_u32 s68, s68, s67
s_and_b32 s67, s52, 3
s_lshl_b32 s31, s68, 15
s_lshl_b32 s69, s67, 8
s_add_u32 s31, s31, s69
s_lshl_b32 s61, s67, 16
s_lshl_b32 s68, s68, 7
s_add_u32 s61, s61, s68
s_add_u32 s61, s61, 458752
s_cmp_ge_u32 s53, 28
s_cbranch_scc1 L_noglu1
buffer_load_dwordx4 v[64:67], v6, s[40:43], s28 offen nt
buffer_load_dwordx4 v[68:71], v6, s[40:43], s28 offen offset:3584 nt
buffer_load_dwordx4 v[72:75], v6, s[44:47], s28 offen nt
buffer_load_dwordx4 v[76:79], v6, s[44:47], s28 offen offset:3584 nt
s_add_u32 s28, s28, 7168
buffer_load_dwordx4 v[80:83], v6, s[40:43], s28 offen nt
buffer_load_dwordx4 v[84:87], v6, s[40:43], s28 offen offset:3584 nt
buffer_load_dwordx4 v[88:91], v6, s[44:47], s28 offen nt
buffer_load_dwordx4 v[92:95], v6, s[44:47], s28 offen offset:3584 nt
s_add_u32 s28, s28, 7168
buffer_load_dwordx4 v[96:99], v6, s[40:43], s28 offen nt
buffer_load_dwordx4 v[100:103], v6, s[40:43], s28 offen offset:3584 nt
buffer_load_dwordx4 v[104:107], v6, s[44:47], s28 offen nt
buffer_load_dwordx4 v[108:111], v6, s[44:47], s28 offen offset:3584 nt
s_add_u32 s28, s28, 7168
buffer_load_dwordx4 v[112:115], v6, s[40:43], s28 offen nt
buffer_load_dwordx4 v[116:119], v6, s[40:43], s28 offen offset:3584 nt
buffer_load_dwordx4 v[120:123], v6, s[44:47], s28 offen nt
buffer_load_dwordx4 v[124:127], v6, s[44:47], s28 offen offset:3584 nt
s_waitcnt vmcnt(12) lgkmcnt(0)
v_perm_b32 v60, v68, v64, s70
v_dot2_f32_bf16 v40, v60, v24, 0
v_perm_b32 v61, v68, v64, s71
v_dot2_f32_bf16 v41, v61, v24, 0
v_perm_b32 v62, v69, v65, s70
v_dot2_f32_bf16 v42, v62, v24, 0
v_perm_b32 v63, v69, v65, s71
v_dot2_f32_bf16 v43, v63, v24, 0
v_perm_b32 v60, v70, v66, s70
v_dot2_f32_bf16 v44, v60, v24, 0
v_perm_b32 v61, v70, v66, s71
v_dot2_f32_bf16 v45, v61, v24, 0
v_perm_b32 v62, v71, v67, s70
v_dot2_f32_bf16 v46, v62, v24, 0
v_perm_b32 v63, v71, v67, s71
v_dot2_f32_bf16 v47, v63, v24, 0
v_perm_b32 v60, v76, v72, s70
v_dot2_f32_bf16 v48, v60, v24, 0
v_perm_b32 v61, v76, v72, s71
v_dot2_f32_bf16 v49, v61, v24, 0
v_perm_b32 v62, v77, v73, s70
v_dot2_f32_bf16 v50, v62, v24, 0
v_perm_b32 v63, v77, v73, s71
v_dot2_f32_bf16 v51, v63, v24, 0
v_perm_b32 v60, v78, v74, s70
v_dot2_f32_bf16 v52, v60, v24, 0
v_perm_b32 v61, v78, v74, s71
v_dot2_f32_bf16 v53, v61, v24, 0
v_perm_b32 v62, v79, v75, s70
v_dot2_f32_bf16 v54, v62, v24, 0
v_perm_b32 v63, v79, v75, s71
v_dot2_f32_bf16 v55, v63, v24, 0
s_waitcnt vmcnt(8) lgkmcnt(0)
v_perm_b32 v60, v84, v80, s70
v_dot2_f32_bf16 v40, v60, v25, v40
v_perm_b32 v61, v84, v80, s71
v_dot2_f32_bf16 v41, v61, v25, v41
v_perm_b32 v62, v85, v81, s70
v_dot2_f32_bf16 v42, v62, v25, v42
v_perm_b32 v63, v85, v81, s71
v_dot2_f32_bf16 v43, v63, v25, v43
v_perm_b32 v60, v86, v82, s70
v_dot2_f32_bf16 v44, v60, v25, v44
v_perm_b32 v61, v86, v82, s71
v_dot2_f32_bf16 v45, v61, v25, v45
v_perm_b32 v62, v87, v83, s70
v_dot2_f32_bf16 v46, v62, v25, v46
v_perm_b32 v63, v87, v83, s71
v_dot2_f32_bf16 v47, v63, v25, v47
v_perm_b32 v60, v92, v88, s70
v_dot2_f32_bf16 v48, v60, v25, v48
v_perm_b32 v61, v92, v88, s71
v_dot2_f32_bf16 v49, v61, v25, v49
v_perm_b32 v62, v93, v89, s70
v_dot2_f32_bf16 v50, v62, v25, v50
v_perm_b32 v63, v93, v89, s71
v_dot2_f32_bf16 v51, v63, v25, v51
v_perm_b32 v60, v94, v90, s70
v_dot2_f32_bf16 v52, v60, v25, v52
v_perm_b32 v61, v94, v90, s71
v_dot2_f32_bf16 v53, v61, v25, v53
v_perm_b32 v62, v95, v91, s70
v_dot2_f32_bf16 v54, v62, v25, v54
v_perm_b32 v63, v95, v91, s71
v_dot2_f32_bf16 v55, v63, v25, v55
s_waitcnt vmcnt(4) lgkmcnt(0)
v_perm_b32 v60, v100, v96, s70
v_dot2_f32_bf16 v40, v60, v26, v40
v_perm_b32 v61, v100, v96, s71
v_dot2_f32_bf16 v41, v61, v26, v41
v_perm_b32 v62, v101, v97, s70
v_dot2_f32_bf16 v42, v62, v26, v42
v_perm_b32 v63, v101, v97, s71
v_dot2_f32_bf16 v43, v63, v26, v43
v_perm_b32 v60, v102, v98, s70
v_dot2_f32_bf16 v44, v60, v26, v44
v_perm_b32 v61, v102, v98, s71
v_dot2_f32_bf16 v45, v61, v26, v45
v_perm_b32 v62, v103, v99, s70
v_dot2_f32_bf16 v46, v62, v26, v46
v_perm_b32 v63, v103, v99, s71
v_dot2_f32_bf16 v47, v63, v26, v47
v_perm_b32 v60, v108, v104, s70
v_dot2_f32_bf16 v48, v60, v26, v48
v_perm_b32 v61, v108, v104, s71
v_dot2_f32_bf16 v49, v61, v26, v49
v_perm_b32 v62, v109, v105, s70
v_dot2_f32_bf16 v50, v62, v26, v50
v_perm_b32 v63, v109, v105, s71
v_dot2_f32_bf16 v51, v63, v26, v51
v_perm_b32 v60, v110, v106, s70
v_dot2_f32_bf16 v52, v60, v26, v52
v_perm_b32 v61, v110, v106, s71
v_dot2_f32_bf16 v53, v61, v26, v53
v_perm_b32 v62, v111, v107, s70
v_dot2_f32_bf16 v54, v62, v26, v54
v_perm_b32 v63, v111, v107, s71
v_dot2_f32_bf16 v55, v63, v26, v55
s_waitcnt vmcnt(0) lgkmcnt(0)
v_perm_b32 v60, v116, v112, s70
v_dot2_f32_bf16 v40, v60, v27, v40
v_perm_b32 v61, v116, v112, s71
v_dot2_f32_bf16 v41, v61, v27, v41
v_perm_b32 v62, v117, v113, s70
v_dot2_f32_bf16 v42, v62, v27, v42
v_perm_b32 v63, v117, v113, s71
v_dot2_f32_bf16 v43, v63, v27, v43
v_perm_b32 v60, v118, v114, s70
v_dot2_f32_bf16 v44, v60, v27, v44
v_perm_b32 v61, v118, v114, s71
v_dot2_f32_bf16 v45, v61, v27, v45
v_perm_b32 v62, v119, v115, s70
v_dot2_f32_bf16 v46, v62, v27, v46
v_perm_b32 v63, v119, v115, s71
v_dot2_f32_bf16 v47, v63, v27, v47
v_perm_b32 v60, v124, v120, s70
v_dot2_f32_bf16 v48, v60, v27, v48
v_perm_b32 v61, v124, v120, s71
v_dot2_f32_bf16 v49, v61, v27, v49
v_perm_b32 v62, v125, v121, s70
v_dot2_f32_bf16 v50, v62, v27, v50
v_perm_b32 v63, v125, v121, s71
v_dot2_f32_bf16 v51, v63, v27, v51
v_perm_b32 v60, v126, v122, s70
v_dot2_f32_bf16 v52, v60, v27, v52
v_perm_b32 v61, v126, v122, s71
v_dot2_f32_bf16 v53, v61, v27, v53
v_perm_b32 v62, v127, v123, s70
v_dot2_f32_bf16 v54, v62, v27, v54
v_perm_b32 v63, v127, v123, s71
v_dot2_f32_bf16 v55, v63, v27, v55
v_permlane32_swap_b32 v40, v44
v_permlane32_swap_b32 v41, v45
v_permlane32_swap_b32 v42, v46
v_permlane32_swap_b32 v43, v47
v_add_f32 v40, v40, v44
v_add_f32 v41, v41, v45
v_add_f32 v42, v42, v46
v_add_f32 v43, v43, v47
s_nop 0
v_permlane16_swap_b32 v40, v42
v_permlane16_swap_b32 v41, v43
v_add_f32 v40, v40, v42
v_add_f32 v41, v41, v43
s_nop 0
v_add_f32_dpp v56, v40, v40 row_ror:8 row_mask:0xf bank_mask:0x3
s_nop 1
v_add_f32_dpp v56, v41, v41 row_ror:8 row_mask:0xf bank_mask:0xc
v_permlane32_swap_b32 v48, v52
v_permlane32_swap_b32 v49, v53
v_permlane32_swap_b32 v50, v54
v_permlane32_swap_b32 v51, v55
v_add_f32 v48, v48, v52
v_add_f32 v49, v49, v53
v_add_f32 v50, v50, v54
v_add_f32 v51, v51, v55
s_nop 0
v_permlane16_swap_b32 v48, v50
v_permlane16_swap_b32 v49, v51
v_add_f32 v48, v48, v50
v_add_f32 v49, v49, v51
s_nop 0
v_add_f32_dpp v57, v48, v48 row_ror:8 row_mask:0xf bank_mask:0x3
s_nop 1
v_add_f32_dpp v57, v49, v49 row_ror:8 row_mask:0xf bank_mask:0xc
L_noglu1:
s_mov_b32 s74, 8388608
L_wtrg:
s_sleep 4
ds_read_b32 v33, v21 offset:2056
s_sub_u32 s74, s74, 1
s_cbranch_scc1 L_wtrg_d
s_waitcnt lgkmcnt(0)
v_cmp_eq_u32 vcc, 0, v33
s_cbranch_vccnz L_wtrg
L_wtrg_d:
s_waitcnt lgkmcnt(0)
v_lshlrev_b32 v248, 12, v0
s_mov_b64 exec, 0xffff
s_lshl_b32 s66, s54, 16
s_lshl_b32 s67, s56, 7
s_add_u32 s66, s66, s67
s_add_u32 s66, s66, 786432
buffer_load_dword v249, v248, s[16:19], s66 offen
s_lshl_b32 s66, s55, 16
s_lshl_b32 s67, s54, 3
s_add_u32 s67, s67, s52
s_lshl_b32 s67, s67, 7
s_add_u32 s66, s66, s67
s_add_u32 s66, s66, 1310720
s_mov_b64 exec, 0xff
v_lshlrev_b32 v248, 13, v0
buffer_load_dword v250, v248, s[16:19], s66 offen
s_and_b32 s66, s52, 3
s_lshl_b32 s66, s66, 16
s_lshr_b32 s67, s52, 2
s_lshl_b32 s68, s53, 1
s_add_u32 s67, s67, s68
s_lshl_b32 s67, s67, 7
s_add_u32 s66, s66, s67
s_add_u32 s66, s66, 458752
buffer_load_dword v251, v248, s[16:19], s66 offen
s_mov_b64 exec, -1
s_cmp_ge_u32 s53, 28
s_cbranch_scc1 L_noglu2
buffer_store_dwordx4 v[56:59], v23, s[16:19], s30 offen sc1
s_add_u32 s30, s29, 4096
s_mov_b32 s74, 1048576
buffer_load_dword v160, v7, s[48:51], s31 offen offset:0 nt
buffer_load_dword v161, v7, s[48:51], s31 offen offset:1024 nt
buffer_load_dword v162, v7, s[48:51], s31 offen offset:2048 nt
buffer_load_dword v163, v7, s[48:51], s31 offen offset:3072 nt
s_add_u32 s31, s31, 4096
buffer_load_dword v164, v7, s[48:51], s31 offen offset:0 nt
buffer_load_dword v165, v7, s[48:51], s31 offen offset:1024 nt
buffer_load_dword v166, v7, s[48:51], s31 offen offset:2048 nt
buffer_load_dword v167, v7, s[48:51], s31 offen offset:3072 nt
s_add_u32 s31, s31, 4096
buffer_load_dword v168, v7, s[48:51], s31 offen offset:0 nt
buffer_load_dword v169, v7, s[48:51], s31 offen offset:1024 nt
buffer_load_dword v170, v7, s[48:51], s31 offen offset:2048 nt
buffer_load_dword v171, v7, s[48:51], s31 offen offset:3072 nt
s_add_u32 s31, s31, 4096
buffer_load_dword v172, v7, s[48:51], s31 offen offset:0 nt
buffer_load_dword v173, v7, s[48:51], s31 offen offset:1024 nt
buffer_load_dword v174, v7, s[48:51], s31 offen offset:2048 nt
buffer_load_dword v175, v7, s[48:51], s31 offen offset:3072 nt
s_add_u32 s31, s31, 4096
buffer_load_dword v176, v7, s[48:51], s31 offen offset:0 nt
buffer_load_dword v177, v7, s[48:51], s31 offen offset:1024 nt
buffer_load_dword v178, v7, s[48:51], s31 offen offset:2048 nt
buffer_load_dword v179, v7, s[48:51], s31 offen offset:3072 nt
s_add_u32 s31, s31, 4096
buffer_load_dword v180, v7, s[48:51], s31 offen offset:0 nt
buffer_load_dword v181, v7, s[48:51], s31 offen offset:1024 nt
buffer_load_dword v182, v7, s[48:51], s31 offen offset:2048 nt
buffer_load_dword v183, v7, s[48:51], s31 offen offset:3072 nt
s_add_u32 s31, s31, 4096
buffer_load_dword v184, v7, s[48:51], s31 offen offset:0 nt
buffer_load_dword v185, v7, s[48:51], s31 offen offset:1024 nt
buffer_load_dword v186, v7, s[48:51], s31 offen offset:2048 nt
buffer_load_dword v187, v7, s[48:51], s31 offen offset:3072 nt
s_add_u32 s31, s31, 4096
buffer_load_dword v188, v7, s[48:51], s31 offen offset:0 nt
buffer_load_dword v189, v7, s[48:51], s31 offen offset:1024 nt
buffer_load_dword v190, v7, s[48:51], s31 offen offset:2048 nt
buffer_load_dword v191, v7, s[48:51], s31 offen offset:3072 nt
v_mov_b32 v96, 0
v_mov_b32 v97, 0
v_mov_b32 v98, 0
v_mov_b32 v99, 0
v_mov_b32 v102, v138
v_mov_b32 v103, v139
L_pollh:
buffer_load_dwordx4 v[72:75], v155, s[16:19], s29 offen offset:0 sc1
buffer_load_dwordx4 v[76:79], v155, s[16:19], s29 offen offset:2048 sc1
buffer_load_dwordx4 v[80:83], v155, s[16:19], s30 offen offset:0 sc1
buffer_load_dwordx4 v[84:87], v155, s[16:19], s30 offen offset:2048 sc1
s_sub_u32 s74, s74, 1
s_cbranch_scc1 L_pollh_done
s_waitcnt vmcnt(0)
v_xor_b32 v88, v74, v58
v_bitop3_b32 v88, v75, v59, v88 bitop3:0xbe
v_bitop3_b32 v88, v78, v58, v88 bitop3:0xbe
v_bitop3_b32 v88, v79, v59, v88 bitop3:0xbe
v_bitop3_b32 v88, v82, v58, v88 bitop3:0xbe
v_bitop3_b32 v88, v83, v59, v88 bitop3:0xbe
v_bitop3_b32 v88, v86, v58, v88 bitop3:0xbe
v_bitop3_b32 v88, v87, v59, v88 bitop3:0xbe
v_cmp_ne_u32 vcc, 0, v88
s_cbranch_vccnz L_pollh
L_pollh_done:
s_waitcnt vmcnt(0)
v_perm_b32 v192, v161, v160, s70
v_perm_b32 v193, v161, v160, s71
v_perm_b32 v194, v163, v162, s70
v_perm_b32 v195, v163, v162, s71
v_perm_b32 v196, v165, v164, s70
v_perm_b32 v197, v165, v164, s71
v_perm_b32 v198, v167, v166, s70
v_perm_b32 v199, v167, v166, s71
v_perm_b32 v200, v169, v168, s70
v_perm_b32 v201, v169, v168, s71
v_perm_b32 v202, v171, v170, s70
v_perm_b32 v203, v171, v170, s71
v_perm_b32 v204, v173, v172, s70
v_perm_b32 v205, v173, v172, s71
v_perm_b32 v206, v175, v174, s70
v_perm_b32 v207, v175, v174, s71
v_perm_b32 v208, v177, v176, s70
v_perm_b32 v209, v177, v176, s71
v_perm_b32 v210, v179, v178, s70
v_perm_b32 v211, v179, v178, s71
v_perm_b32 v212, v181, v180, s70
v_perm_b32 v213, v181, v180, s71
v_perm_b32 v214, v183, v182, s70
v_perm_b32 v215, v183, v182, s71
v_perm_b32 v216, v185, v184, s70
v_perm_b32 v217, v185, v184, s71
v_perm_b32 v218, v187, v186, s70
v_perm_b32 v219, v187, v186, s71
v_perm_b32 v220, v189, v188, s70
v_perm_b32 v221, v189, v188, s71
v_perm_b32 v222, v191, v190, s70
v_perm_b32 v223, v191, v190, s71
v_add_f32 v88, v72, v76
v_add_f32 v89, v73, v77
v_add_f32 v90, v80, v84
v_add_f32 v91, v81, v85
v_add_f32 v88, v88, v90
v_add_f32 v89, v89, v91
s_nop 1
v_permlane32_swap_b32 v88, v89
v_add_f32 v89, v88, v89
v_mov_b32 v88, v89
s_nop 1
v_permlane32_swap_b32 v88, v89
v_cvt_pk_bf16_f32 v88, v88, v88
v_lshlrev_b32 v88, 16, v88
v_cvt_pk_bf16_f32 v89, v89, v89
v_lshlrev_b32 v89, 16, v89
v_mul_f32 v90, s73, v88
v_exp_f32 v90, -v90
s_nop 0
v_add_f32 v90, 1.0, v90
v_rcp_f32 v90, v90
s_nop 0
v_mul_f32 v88, v88, v90
v_cvt_pk_bf16_f32 v88, v88, v88
v_lshlrev_b32 v88, 16, v88
v_mul_f32 v88, v88, v89
s_nop 1
v_mov_b32_dpp v89, v88 quad_perm:[1,1,3,3] row_mask:0xf bank_mask:0xf
v_cvt_pk_bf16_f32 v89, v88, v89
v_mov_b32 v88, v89
s_nop 1
v_permlane16_swap_b32 v88, v89
s_nop 1
v_dot2c_f32_bf16_dpp v96, v88, v192 row_newbcast:0 row_mask:0xf bank_mask:0xf
v_dot2c_f32_bf16_dpp v97, v88, v193 row_newbcast:0 row_mask:0xf bank_mask:0xf
v_dot2c_f32_bf16_dpp v98, v88, v194 row_newbcast:2 row_mask:0xf bank_mask:0xf
v_dot2c_f32_bf16_dpp v99, v88, v195 row_newbcast:2 row_mask:0xf bank_mask:0xf
v_dot2c_f32_bf16_dpp v96, v88, v196 row_newbcast:4 row_mask:0xf bank_mask:0xf
v_dot2c_f32_bf16_dpp v97, v88, v197 row_newbcast:4 row_mask:0xf bank_mask:0xf
v_dot2c_f32_bf16_dpp v98, v88, v198 row_newbcast:6 row_mask:0xf bank_mask:0xf
v_dot2c_f32_bf16_dpp v99, v88, v199 row_newbcast:6 row_mask:0xf bank_mask:0xf
v_dot2c_f32_bf16_dpp v96, v88, v200 row_newbcast:8 row_mask:0xf bank_mask:0xf
v_dot2c_f32_bf16_dpp v97, v88, v201 row_newbcast:8 row_mask:0xf bank_mask:0xf
v_dot2c_f32_bf16_dpp v98, v88, v202 row_newbcast:10 row_mask:0xf bank_mask:0xf
v_dot2c_f32_bf16_dpp v99, v88, v203 row_newbcast:10 row_mask:0xf bank_mask:0xf
v_dot2c_f32_bf16_dpp v96, v88, v204 row_newbcast:12 row_mask:0xf bank_mask:0xf
v_dot2c_f32_bf16_dpp v97, v88, v205 row_newbcast:12 row_mask:0xf bank_mask:0xf
v_dot2c_f32_bf16_dpp v98, v88, v206 row_newbcast:14 row_mask:0xf bank_mask:0xf
v_dot2c_f32_bf16_dpp v99, v88, v207 row_newbcast:14 row_mask:0xf bank_mask:0xf
v_dot2c_f32_bf16_dpp v96, v89, v208 row_newbcast:0 row_mask:0xf bank_mask:0xf
v_dot2c_f32_bf16_dpp v97, v89, v209 row_newbcast:0 row_mask:0xf bank_mask:0xf
v_dot2c_f32_bf16_dpp v98, v89, v210 row_newbcast:2 row_mask:0xf bank_mask:0xf
v_dot2c_f32_bf16_dpp v99, v89, v211 row_newbcast:2 row_mask:0xf bank_mask:0xf
v_dot2c_f32_bf16_dpp v96, v89, v212 row_newbcast:4 row_mask:0xf bank_mask:0xf
v_dot2c_f32_bf16_dpp v97, v89, v213 row_newbcast:4 row_mask:0xf bank_mask:0xf
v_dot2c_f32_bf16_dpp v98, v89, v214 row_newbcast:6 row_mask:0xf bank_mask:0xf
v_dot2c_f32_bf16_dpp v99, v89, v215 row_newbcast:6 row_mask:0xf bank_mask:0xf
v_dot2c_f32_bf16_dpp v96, v89, v216 row_newbcast:8 row_mask:0xf bank_mask:0xf
v_dot2c_f32_bf16_dpp v97, v89, v217 row_newbcast:8 row_mask:0xf bank_mask:0xf
v_dot2c_f32_bf16_dpp v98, v89, v218 row_newbcast:10 row_mask:0xf bank_mask:0xf
v_dot2c_f32_bf16_dpp v99, v89, v219 row_newbcast:10 row_mask:0xf bank_mask:0xf
v_dot2c_f32_bf16_dpp v96, v89, v220 row_newbcast:12 row_mask:0xf bank_mask:0xf
v_dot2c_f32_bf16_dpp v97, v89, v221 row_newbcast:12 row_mask:0xf bank_mask:0xf
v_dot2c_f32_bf16_dpp v98, v89, v222 row_newbcast:14 row_mask:0xf bank_mask:0xf
v_dot2c_f32_bf16_dpp v99, v89, v223 row_newbcast:14 row_mask:0xf bank_mask:0xf
s_nop 1
v_add_f32 v100, v96, v98
v_add_f32 v101, v97, v99
L_noglu2:
buffer_load_dwordx2 v[116:117], v154, s[20:23], s89 offen nt
s_add_u32 s89, s89, 16384
buffer_load_dwordx2 v[118:119], v154, s[20:23], s89 offen nt
s_add_u32 s89, s89, 16384
buffer_load_dwordx2 v[120:121], v154, s[20:23], s89 offen nt
s_add_u32 s89, s89, 16384
buffer_load_dwordx2 v[122:123], v154, s[20:23], s89 offen nt
s_add_u32 s89, s89, 16384
buffer_load_dwordx2 v[124:125], v154, s[20:23], s89 offen nt
s_add_u32 s89, s89, 16384
buffer_load_dwordx2 v[126:127], v154, s[20:23], s89 offen nt
s_add_u32 s89, s89, 16384
buffer_load_dwordx2 v[128:129], v154, s[20:23], s89 offen nt
s_add_u32 s89, s89, 16384
buffer_load_dwordx2 v[130:131], v154, s[20:23], s89 offen nt
L_tail:
s_waitcnt lgkmcnt(0)
v_mov_b32 v39, v138
s_barrier
ds_read_b64 v[20:21], v141 offset:2080
ds_read_b64 v[22:23], v141 offset:2112
ds_read_b64 v[24:25], v141 offset:2144
ds_read_b128 v[72:75], v140 offset:2176
ds_read_b128 v[76:79], v140 offset:4288
ds_read_b128 v[80:83], v140 offset:6400
s_waitcnt lgkmcnt(3)
v_max3_f32 v32, v20, v22, v24
v_sub_f32 v20, v20, v32
v_sub_f32 v22, v22, v32
v_sub_f32 v24, v24, v32
v_exp_f32 v20, v20
v_exp_f32 v22, v22
v_exp_f32 v24, v24
v_mul_f32 v33, v21, v20
v_fmac_f32 v33, v23, v22
v_fmac_f32 v33, v25, v24
s_mov_b32 exec_hi, 0
s_waitcnt lgkmcnt(1)
v_mul_f32 v72, v72, v20
v_mul_f32 v73, v73, v20
v_mul_f32 v74, v74, v20
v_mul_f32 v75, v75, v20
v_fmac_f32 v72, v76, v22
v_fmac_f32 v73, v77, v22
v_fmac_f32 v74, v78, v22
v_fmac_f32 v75, v79, v22
v_cndmask_b32 v38, v32, v33, s[82:83]
s_waitcnt lgkmcnt(0)
v_fmac_f32 v72, v80, v24
v_fmac_f32 v73, v81, v24
v_fmac_f32 v74, v82, v24
v_fmac_f32 v75, v83, v24
v_cvt_pk_bf16_f32 v36, v72, v73
v_cvt_pk_bf16_f32 v37, v74, v75
buffer_store_dwordx4 v[36:39], v142, s[16:19], s76 offen sc1
s_mov_b64 exec, -1
s_mov_b32 s74, 1048576
v_mov_b32 v44, 0
v_mov_b32 v45, 0
v_mov_b32 v46, 0
v_mov_b32 v47, 0
v_mov_b32 v70, v138
v_mov_b32 v71, v139
s_waitcnt vmcnt(1)
v_permlane32_swap_b32 v116, v117
v_permlane32_swap_b32 v118, v119
v_permlane32_swap_b32 v120, v121
v_permlane32_swap_b32 v122, v123
v_permlane32_swap_b32 v124, v125
v_permlane32_swap_b32 v126, v127
v_permlane32_swap_b32 v128, v129
v_permlane32_swap_b32 v130, v131
v_perm_b32 v52, v117, v116, s70
v_perm_b32 v53, v117, v116, s71
v_perm_b32 v54, v119, v118, s70
v_perm_b32 v55, v119, v118, s71
v_perm_b32 v56, v121, v120, s70
v_perm_b32 v57, v121, v120, s71
v_perm_b32 v58, v123, v122, s70
v_perm_b32 v59, v123, v122, s71
v_perm_b32 v60, v125, v124, s70
v_perm_b32 v61, v125, v124, s71
v_perm_b32 v62, v127, v126, s70
v_perm_b32 v63, v127, v126, s71
v_perm_b32 v64, v129, v128, s70
v_perm_b32 v65, v129, v128, s71
v_perm_b32 v66, v131, v130, s70
v_perm_b32 v67, v131, v130, s71
buffer_load_dwordx4 v[20:23], v156, s[16:19], s78 offen offset:0 sc1
buffer_load_dwordx4 v[24:27], v156, s[16:19], s78 offen offset:2048 sc1
s_cmp_lg_u32 s3, 0
s_cbranch_scc1 L_poll1
s_cmp_ge_u32 s53, 28
s_cbranch_scc1 L_poll1
buffer_store_dwordx4 v[100:103], v145, s[16:19], s61 offen sc1
s_waitcnt vmcnt(1)
s_branch L_poll1c
L_poll1:
s_waitcnt vmcnt(0)
L_poll1c:
v_cmp_ne_u32 s[90:91], v23, v138
v_cmp_ne_u32 s[92:93], v27, v138
v_mov_b32_dpp v36, v22 quad_perm:[0,0,2,2] row_mask:0xf bank_mask:0xf
v_mov_b32_dpp v37, v26 quad_perm:[0,0,2,2] row_mask:0xf bank_mask:0xf
v_lshlrev_b32 v28, 16, v20
v_max_f32 v41, v36, v37
v_and_b32 v29, 0xffff0000, v20
v_lshlrev_b32 v30, 16, v21
s_or_b64 s[66:67], s[90:91], s[92:93]
s_cbranch_scc0 L_poll1_done
s_sub_u32 s74, s74, 1
s_cbranch_scc1 L_poll1_done
s_cmp_eq_u64 s[90:91], 0
s_cbranch_scc1 L_poll1_s0
buffer_load_dwordx4 v[20:23], v156, s[16:19], s78 offen offset:0 sc1
L_poll1_s0:
s_cmp_eq_u64 s[92:93], 0
s_cbranch_scc1 L_poll1_s1
buffer_load_dwordx4 v[24:27], v156, s[16:19], s78 offen offset:2048 sc1
L_poll1_s1:
s_branch L_poll1
L_poll1_done:
v_max_f32_dpp v41, v41, v41 row_ror:4 row_mask:0xf bank_mask:0xf
v_and_b32 v31, 0xffff0000, v21
v_lshlrev_b32 v32, 16, v24
v_max_f32_dpp v41, v41, v41 row_ror:8 row_mask:0xf bank_mask:0xf
v_mov_b32 v42, v41
v_and_b32 v33, 0xffff0000, v24
v_lshlrev_b32 v34, 16, v25
v_permlane16_swap_b32 v42, v41
v_max_f32 v41, v41, v42
v_mov_b32 v42, v41
v_and_b32 v35, 0xffff0000, v25
s_nop 0
v_permlane32_swap_b32 v42, v41
v_max_f32 v41, v41, v42
v_sub_f32 v36, v36, v41
v_sub_f32 v37, v37, v41
v_exp_f32 v36, v36
v_exp_f32 v37, v37
v_mul_f32 v28, v28, v36
v_mul_f32 v29, v29, v36
v_mul_f32 v30, v30, v36
v_mul_f32 v31, v31, v36
v_mul_f32 v22, v22, v36
v_fmac_f32 v28, v32, v37
v_fmac_f32 v29, v33, v37
v_fmac_f32 v30, v34, v37
v_fmac_f32 v31, v35, v37
v_fmac_f32 v22, v26, v37
v_permlane32_swap_b32 v28, v29
v_mov_b32 v26, v22
v_permlane32_swap_b32 v30, v31
v_add_f32 v28, v28, v29
v_permlane32_swap_b32 v26, v22
v_add_f32 v30, v30, v31
v_add_f32 v22, v22, v26
v_mov_b32 v26, v22
v_permlane16_swap_b32 v28, v30
v_add_f32 v28, v28, v30
v_permlane16_swap_b32 v26, v22
v_add_f32 v22, v22, v26
v_add_f32_dpp v28, v28, v28 row_ror:4 row_mask:0xf bank_mask:0xf
s_nop 0
v_add_f32_dpp v22, v22, v22 row_ror:4 row_mask:0xf bank_mask:0xf
v_add_f32_dpp v28, v28, v28 row_ror:8 row_mask:0xf bank_mask:0xf
s_nop 0
v_add_f32_dpp v22, v22, v22 row_ror:8 row_mask:0xf bank_mask:0xf
s_nop 1
v_rcp_f32_dpp v22, v22 quad_perm:[1,1,3,3] row_mask:0xf bank_mask:0xf
s_nop 0
v_mul_f32 v28, v28, v22
v_mov_b32 v29, v28
s_nop 1
v_permlane32_swap_b32 v29, v28
v_cvt_pk_bf16_f32 v28, v29, v28
v_mov_b32 v29, v28
s_nop 1
v_permlane16_swap_b32 v29, v28
s_nop 1
v_dot2c_f32_bf16_dpp v44, v29, v52 row_newbcast:0 row_mask:0xf bank_mask:0xf
v_dot2c_f32_bf16_dpp v45, v29, v53 row_newbcast:0 row_mask:0xf bank_mask:0xf
v_dot2c_f32_bf16_dpp v46, v28, v54 row_newbcast:0 row_mask:0xf bank_mask:0xf
v_dot2c_f32_bf16_dpp v47, v28, v55 row_newbcast:0 row_mask:0xf bank_mask:0xf
v_dot2c_f32_bf16_dpp v44, v29, v56 row_newbcast:1 row_mask:0xf bank_mask:0xf
v_dot2c_f32_bf16_dpp v45, v29, v57 row_newbcast:1 row_mask:0xf bank_mask:0xf
v_dot2c_f32_bf16_dpp v46, v28, v58 row_newbcast:1 row_mask:0xf bank_mask:0xf
v_dot2c_f32_bf16_dpp v47, v28, v59 row_newbcast:1 row_mask:0xf bank_mask:0xf
v_dot2c_f32_bf16_dpp v44, v29, v60 row_newbcast:2 row_mask:0xf bank_mask:0xf
v_dot2c_f32_bf16_dpp v45, v29, v61 row_newbcast:2 row_mask:0xf bank_mask:0xf
v_dot2c_f32_bf16_dpp v46, v28, v62 row_newbcast:2 row_mask:0xf bank_mask:0xf
v_dot2c_f32_bf16_dpp v47, v28, v63 row_newbcast:2 row_mask:0xf bank_mask:0xf
v_dot2c_f32_bf16_dpp v44, v29, v64 row_newbcast:3 row_mask:0xf bank_mask:0xf
v_dot2c_f32_bf16_dpp v45, v29, v65 row_newbcast:3 row_mask:0xf bank_mask:0xf
v_dot2c_f32_bf16_dpp v46, v28, v66 row_newbcast:3 row_mask:0xf bank_mask:0xf
v_dot2c_f32_bf16_dpp v47, v28, v67 row_newbcast:3 row_mask:0xf bank_mask:0xf
s_nop 1
v_add_f32 v44, v44, v46
v_add_f32 v45, v45, v47
ds_write_b64 v144, v[44:45] offset:0
s_waitcnt lgkmcnt(0)
s_barrier
s_cmp_lg_u32 s3, 0
s_cbranch_scc1 L_notpub
ds_read_b64 v[20:21], v151 offset:0
ds_read_b64 v[22:23], v151 offset:512
ds_read_b64 v[24:25], v151 offset:1024
ds_read_b64 v[26:27], v151 offset:1536
s_waitcnt lgkmcnt(2)
v_add_f32 v20, v20, v22
v_add_f32 v21, v21, v23
s_waitcnt lgkmcnt(0)
v_add_f32 v24, v24, v26
v_add_f32 v25, v25, v27
v_add_f32 v68, v20, v24
v_add_f32 v69, v21, v25
buffer_store_dwordx4 v[68:71], v145, s[16:19], s80 offen sc1
s_branch L_done
L_notpub:
s_cmp_lg_u32 s3, 1
s_cbranch_scc1 L_done
s_cmp_eq_u32 s59, -1
s_cbranch_scc1 L_done
s_mov_b32 s74, 1048576
s_add_u32 s79, s87, 4096
s_add_u32 s75, s81, 4096
buffer_load_ushort v147, v146, s[32:35], s88 offen
buffer_load_dwordx4 v[72:75], v143, s[16:19], s87 offen offset:0 sc1
buffer_load_dwordx4 v[76:79], v143, s[16:19], s87 offen offset:1024 sc1
buffer_load_dwordx4 v[80:83], v143, s[16:19], s87 offen offset:2048 sc1
buffer_load_dwordx4 v[84:87], v143, s[16:19], s87 offen offset:3072 sc1
buffer_load_dwordx4 v[88:91], v143, s[16:19], s79 offen offset:0 sc1
buffer_load_dwordx4 v[92:95], v143, s[16:19], s79 offen offset:1024 sc1
buffer_load_dwordx4 v[96:99], v143, s[16:19], s79 offen offset:2048 sc1
L_pollg:
s_waitcnt vmcnt(0)
v_cmp_ne_u64 s[90:91], v[74:75], v[138:139]
v_cmp_ne_u64 s[92:93], v[78:79], v[138:139]
v_cmp_ne_u64 s[94:95], v[82:83], v[138:139]
v_cmp_ne_u64 s[84:85], v[86:87], v[138:139]
v_cmp_ne_u64 s[4:5], v[90:91], v[138:139]
v_cmp_ne_u64 s[6:7], v[94:95], v[138:139]
v_cmp_ne_u64 s[26:27], v[98:99], v[138:139]
s_or_b64 s[66:67], s[90:91], s[92:93]
s_or_b64 s[66:67], s[66:67], s[94:95]
s_or_b64 s[66:67], s[66:67], s[84:85]
s_or_b64 s[66:67], s[66:67], s[4:5]
s_or_b64 s[66:67], s[66:67], s[6:7]
s_or_b64 s[66:67], s[66:67], s[26:27]
s_cbranch_scc0 L_pollg_done
s_sub_u32 s74, s74, 1
s_cbranch_scc1 L_pollg_done
s_cmp_eq_u64 s[90:91], 0
s_cbranch_scc1 L_pollg_s0
buffer_load_dwordx4 v[72:75], v143, s[16:19], s87 offen offset:0 sc1
L_pollg_s0:
s_cmp_eq_u64 s[92:93], 0
s_cbranch_scc1 L_pollg_s1
buffer_load_dwordx4 v[76:79], v143, s[16:19], s87 offen offset:1024 sc1
L_pollg_s1:
s_cmp_eq_u64 s[94:95], 0
s_cbranch_scc1 L_pollg_s2
buffer_load_dwordx4 v[80:83], v143, s[16:19], s87 offen offset:2048 sc1
L_pollg_s2:
s_cmp_eq_u64 s[84:85], 0
s_cbranch_scc1 L_pollg_s3
buffer_load_dwordx4 v[84:87], v143, s[16:19], s87 offen offset:3072 sc1
L_pollg_s3:
s_cmp_eq_u64 s[4:5], 0
s_cbranch_scc1 L_pollg_s4
buffer_load_dwordx4 v[88:91], v143, s[16:19], s79 offen offset:0 sc1
L_pollg_s4:
s_cmp_eq_u64 s[6:7], 0
s_cbranch_scc1 L_pollg_s5
buffer_load_dwordx4 v[92:95], v143, s[16:19], s79 offen offset:1024 sc1
L_pollg_s5:
s_cmp_eq_u64 s[26:27], 0
s_cbranch_scc1 L_pollg_s6
buffer_load_dwordx4 v[96:99], v143, s[16:19], s79 offen offset:2048 sc1
L_pollg_s6:
s_branch L_pollg
L_pollg_done:
s_cmp_lg_u32 s59, 0
s_cbranch_scc1 L_nonon
s_mov_b32 s66, 163840
s_mov_b64 exec, 1
buffer_store_dwordx2 v[138:139], v148, s[16:19], s66 offen sc1
s_mov_b64 exec, -1
L_nonon:
v_add_f32 v106, v72, v76
v_add_f32 v104, v80, v84
v_add_f32 v105, v88, v92
v_add_f32 v106, v106, v104
v_add_f32 v105, v105, v96
v_add_f32 v106, v106, v105
v_add_f32 v107, v73, v77
v_add_f32 v104, v81, v85
v_add_f32 v105, v89, v93
v_add_f32 v107, v107, v104
v_add_f32 v105, v105, v97
v_add_f32 v107, v107, v105
s_nop 1
v_permlane32_swap_b32 v106, v107
v_add_f32 v106, v106, v107
v_mov_b32 v104, v106
s_nop 1
v_permlane16_swap_b32 v104, v106
v_add_f32 v106, v106, v104
s_nop 1
v_add_f32_dpp v106, v106, v106 row_ror:8 row_mask:0xf bank_mask:0xf
v_cvt_pk_bf16_f32 v106, v106, v106
v_lshlrev_b32 v106, 16, v106
v_mul_f32 v107, s73, v106
v_exp_f32 v107, -v107
s_nop 0
v_add_f32 v107, 1.0, v107
v_rcp_f32 v107, v107
s_nop 0
v_mul_f32 v106, v106, v107
v_cvt_pk_bf16_f32 v106, v106, v106
v_lshlrev_b32 v106, 16, v106
v_lshlrev_b32 v147, 16, v147
buffer_load_dwordx4 v[20:23], v143, s[16:19], s81 offen offset:0 sc1
buffer_load_dwordx4 v[24:27], v143, s[16:19], s81 offen offset:1024 sc1
buffer_load_dwordx4 v[28:31], v143, s[16:19], s81 offen offset:2048 sc1
buffer_load_dwordx4 v[32:35], v143, s[16:19], s81 offen offset:3072 sc1
buffer_load_dwordx4 v[36:39], v143, s[16:19], s75 offen offset:0 sc1
buffer_load_dwordx4 v[40:43], v143, s[16:19], s75 offen offset:1024 sc1
buffer_load_dwordx4 v[44:47], v143, s[16:19], s75 offen offset:2048 sc1
buffer_load_dwordx4 v[48:51], v143, s[16:19], s75 offen offset:3072 sc1
s_mov_b32 s74, 1048576
L_poll2:
s_waitcnt vmcnt(0)
v_cmp_ne_u64 s[90:91], v[22:23], v[138:139]
v_cmp_ne_u64 s[92:93], v[26:27], v[138:139]
v_cmp_ne_u64 s[94:95], v[30:31], v[138:139]
v_cmp_ne_u64 s[84:85], v[34:35], v[138:139]
v_cmp_ne_u64 s[4:5], v[38:39], v[138:139]
v_cmp_ne_u64 s[6:7], v[42:43], v[138:139]
v_cmp_ne_u64 s[26:27], v[46:47], v[138:139]
v_cmp_ne_u64 s[24:25], v[50:51], v[138:139]
v_add_f32 v108, v20, v24
v_add_f32 v104, v28, v32
v_add_f32 v105, v36, v40
v_add_f32 v108, v108, v104
v_add_f32 v105, v105, v44
v_add_f32 v108, v108, v48
v_add_f32 v108, v108, v105
v_add_f32 v109, v21, v25
v_add_f32 v104, v29, v33
v_add_f32 v105, v37, v41
v_add_f32 v109, v109, v104
v_add_f32 v105, v105, v45
v_add_f32 v109, v109, v49
v_add_f32 v109, v109, v105
s_or_b64 s[66:67], s[90:91], s[92:93]
s_or_b64 s[66:67], s[66:67], s[94:95]
s_or_b64 s[66:67], s[66:67], s[84:85]
s_or_b64 s[66:67], s[66:67], s[4:5]
s_or_b64 s[66:67], s[66:67], s[6:7]
s_or_b64 s[66:67], s[66:67], s[26:27]
s_or_b64 s[66:67], s[66:67], s[24:25]
s_cbranch_scc0 L_poll2_done
s_sub_u32 s74, s74, 1
s_cbranch_scc1 L_poll2_done
s_cmp_eq_u64 s[90:91], 0
s_cbranch_scc1 L_poll2_s0
buffer_load_dwordx4 v[20:23], v143, s[16:19], s81 offen offset:0 sc1
L_poll2_s0:
s_cmp_eq_u64 s[92:93], 0
s_cbranch_scc1 L_poll2_s1
buffer_load_dwordx4 v[24:27], v143, s[16:19], s81 offen offset:1024 sc1
L_poll2_s1:
s_cmp_eq_u64 s[94:95], 0
s_cbranch_scc1 L_poll2_s2
buffer_load_dwordx4 v[28:31], v143, s[16:19], s81 offen offset:2048 sc1
L_poll2_s2:
s_cmp_eq_u64 s[84:85], 0
s_cbranch_scc1 L_poll2_s3
buffer_load_dwordx4 v[32:35], v143, s[16:19], s81 offen offset:3072 sc1
L_poll2_s3:
s_cmp_eq_u64 s[4:5], 0
s_cbranch_scc1 L_poll2_s4
buffer_load_dwordx4 v[36:39], v143, s[16:19], s75 offen offset:0 sc1
L_poll2_s4:
s_cmp_eq_u64 s[6:7], 0
s_cbranch_scc1 L_poll2_s5
buffer_load_dwordx4 v[40:43], v143, s[16:19], s75 offen offset:1024 sc1
L_poll2_s5:
s_cmp_eq_u64 s[26:27], 0
s_cbranch_scc1 L_poll2_s6
buffer_load_dwordx4 v[44:47], v143, s[16:19], s75 offen offset:2048 sc1
L_poll2_s6:
s_cmp_eq_u64 s[24:25], 0
s_cbranch_scc1 L_poll2_s7
buffer_load_dwordx4 v[48:51], v143, s[16:19], s75 offen offset:3072 sc1
L_poll2_s7:
s_branch L_poll2
L_poll2_done:
v_permlane32_swap_b32 v108, v109
v_add_f32 v108, v108, v109
v_mov_b32 v104, v108
s_nop 1
v_permlane16_swap_b32 v104, v108
v_add_f32 v108, v108, v104
s_nop 1
v_add_f32_dpp v108, v108, v108 row_ror:8 row_mask:0xf bank_mask:0xf
v_cvt_pk_bf16_f32 v108, v108, v108
v_lshlrev_b32 v108, 16, v108
v_mul_f32 v108, v108, v106
v_cvt_pk_bf16_f32 v108, v108, v108
v_lshlrev_b32 v108, 16, v108
v_add_f32 v108, v108, v147
v_cvt_pk_bf16_f32 v108, v108, v108
s_mov_b32 exec_lo, 0xff
s_mov_b32 exec_hi, 0xff
buffer_store_short v108, v146, s[36:39], s88 offen sc1
s_mov_b64 exec, -1
L_done:
L_end:
s_endpgm
.section .rodata,"a"
.p2align 6
.amdhsa_kernel recurrent_scan__gqa_block_cached__glu_gated_swiglu__decode_kernel
.amdhsa_next_free_vgpr 512
.amdhsa_next_free_sgpr 102
.amdhsa_accum_offset 256
.amdhsa_group_segment_fixed_size 0
.amdhsa_kernarg_size 96
.amdhsa_user_sgpr_count 2
.amdhsa_user_sgpr_kernarg_segment_ptr 1
.amdhsa_system_sgpr_workgroup_id_x 1
.amdhsa_float_denorm_mode_32 3
.end_amdhsa_kernel
```
